```python
import torch

def _softmax(x, axis=-1):
    return torch.softmax(x, dim=axis)
def _gelu(x):
    return torch.nn.functional.gelu(x, approximate="tanh")
def _silu(x):
    return torch.nn.functional.silu(x)
def _sigmoid(x):
    return torch.sigmoid(x)
def _layernorm(x, axis=-1, eps=1e-5):
    m = x.mean(dim=axis, keepdim=True)
    v = x.var(dim=axis, keepdim=True, unbiased=False)
    return (x - m) / torch.sqrt(v + eps)
def _scatter_add(tgt, idx, src, axis=0):
    return tgt.clone().index_add_(axis, idx, src)
def _segment_sum(src, seg, n):
    out = torch.zeros((n,) + src.shape[1:], dtype=src.dtype)
    return out.index_add_(0, seg, src)
def _pad(x, pw):
    flat = tuple(v for pair in reversed(pw) for v in pair)
    return torch.nn.functional.pad(x, flat)

kernel_name = 'gated_mix__grouped_kv_mqa__dense_activation_squared_relu__prompt'

def setup_inputs():

    _w = (lambda a: (lambda t: t.to(torch.bfloat16) if t.is_floating_point() else t)(torch.as_tensor(a)))
    def _A_setup():
        B, S, D, H = 1, 2048, 512, 32
        Dh = D // H
        return {
            "x": _w((lambda *s: torch.randn(*s, dtype=torch.bfloat16) * 0.05)(B, S, D)),
            "wq": _w((lambda *s: torch.randn(*s, dtype=torch.bfloat16) * 0.8)(D, H * Dh)),
            "wk": _w((lambda *s: torch.randn(*s, dtype=torch.bfloat16) * 0.8)(D, Dh)),
            "wv": _w((lambda *s: torch.randn(*s, dtype=torch.bfloat16) * 0.2)(D, Dh)),
            "wo": _w((lambda *s: torch.randn(*s, dtype=torch.bfloat16) * 0.2)(H * Dh, D)),
        }
    _A_in = _A_setup()

    def _B_setup():
        B, S, D, F = 1, 2048, 512, 1792
        return {
            "x": _w((lambda *s: torch.randn(*s, dtype=torch.bfloat16) * 0.05)(B, S, D)),
            "w1": _w((lambda *s: torch.randn(*s, dtype=torch.bfloat16) * 0.05)(D, F)),
            "b1": _w((lambda *s: torch.randn(*s, dtype=torch.bfloat16) * 0.05)(F)),
            "w2": _w((lambda *s: torch.randn(*s, dtype=torch.bfloat16) * 0.05)(F, D)),
            "b2": _w((lambda *s: torch.randn(*s, dtype=torch.bfloat16) * 0.05)(D)),
        }
    _B_in = _B_setup()

    return {
        "A_x": _A_in["x"],
        "A_wq": _A_in["wq"],
        "A_wk": _A_in["wk"],
        "A_wv": _A_in["wv"],
        "A_wo": _A_in["wo"],
        "B_x": _B_in["x"],
        "B_w1": _B_in["w1"],
        "B_b1": _B_in["b1"],
        "B_w2": _B_in["w2"],
        "B_b2": _B_in["b2"],
        "gate_w": _w((lambda *s: torch.randn(*s, dtype=torch.bfloat16) * 0.05)(512) * 16.0),
    }

def reference(A_x, A_wq, A_wk, A_wv, A_wo, B_x, B_w1, B_b1, B_w2, B_b2, gate_w):
    def _A_ref(x, wq, wk, wv, wo):
        B, S, D = x.shape
        H = 32
        Dh = D // H
        q = (lambda x, *d: x.permute(*d))((x @ wq).reshape(B, S, H, Dh), 0, 2, 1, 3)
        k = x @ wk
        v = x @ wv
        scores = torch.einsum("bhqd,bkd->bhqk", q, k) * (Dh ** -0.5)
        p = _softmax(scores, axis=-1)
        o = torch.einsum("bhqk,bkd->bhqd", p, v)
        return (lambda x, *d: x.permute(*d))(o, 0, 2, 1, 3).reshape(B, S, H * Dh) @ wo

    def _B_ref(x, w1, b1, w2, b2):
        h = torch.einsum("bsd,df->bsf", x, w1) + b1
        zero = torch.zeros_like(h)
        r = torch.where(h > zero, h, zero)
        h = r * r
        out = torch.einsum("bsf,fd->bsd", h, w2) + b2
        return out

    x = A_x
    g = _sigmoid((x * gate_w).sum(-1, keepdims=True))
    a = _A_ref(x, A_wq, A_wk, A_wv, A_wo)
    b = _B_ref(x, B_w1, B_b1, B_w2, B_b2)
    return g * a + (1 - g) * b
```

```asm
; @launch grid=(256,1,1) block=(512,1,1) lds=163840
.amdgcn_target "amdgcn-amd-amdhsa--gfx950"
.text
.globl gated_mix__grouped_kv_mqa__dense_activation_squared_relu__prompt_kernel
.p2align 8
.type gated_mix__grouped_kv_mqa__dense_activation_squared_relu__prompt_kernel,@function
gated_mix__grouped_kv_mqa__dense_activation_squared_relu__prompt_kernel:
    s_cmp_ge_u32 s2, 256
    s_cbranch_scc1 L_end
    s_load_dwordx16 s[16:31], s[0:1], 0
    s_load_dwordx8 s[32:39], s[0:1], 64
    s_load_dwordx4 s[40:43], s[0:1], 96
    s_getpc_b64 s[44:45]
L_pc:
    s_mov_b32 s46, L_code_end-L_pc
    s_mov_b32 s47, 0x20000
    s_lshr_b32 s7, s2, 3
    s_lshl_b32 s6, s7, 11
    v_lshlrev_b32 v1, 2, v0
    buffer_load_dword v255, v1, s[44:47], s6 offen
    v_lshrrev_b32 v1, 6, v0
    v_and_b32 v0, 63, v0
    v_readfirstlane_b32 s3, v1
    s_and_b32 s6, s2, 1
    s_lshl_b32 s6, s6, 2
    s_and_b32 s5, s7, 3
    s_add_u32 s5, s5, s6
    s_lshr_b32 s15, s7, 2
    s_and_b32 s6, s2, 6
    s_lshl_b32 s6, s6, 2
    s_add_u32 s4, s6, s15
    v_lshlrev_b32 v2, 4, v0
    s_cmp_ge_u32 s3, 4
    s_cbranch_scc1 L_G
    v_lshrrev_b32 v14, 3, v0
    v_mul_u32_u24 v12, 1024, v14
    v_bfe_u32 v14, v0, 4, 1
    v_lshlrev_b32 v14, 2, v14
    v_xor_b32 v14, v14, v0
    v_and_b32 v14, 7, v14
    v_lshl_add_u32 v12, v14, 4, v12
    v_add_u32 v13, 7168, v12
    s_lshl_b32 s9, s3, 15
    s_lshl_b32 s10, s5, 7
    s_add_u32 s9, s9, s10
    s_lshl_b32 s10, s15, 16
    s_add_u32 s9, s9, s10
    s_lshl_b32 s8, s3, 12
    s_add_u32 s8, s8, 65536
    s_waitcnt lgkmcnt(0)
    s_mov_b32 s48, s18
    s_mov_b32 s49, s19
    s_mov_b32 s50, 0x80000
    s_mov_b32 s51, 0x20000
    s_add_u32 s10, s9, 0
    s_and_b32 s10, s10, 0x7ffff
    s_add_u32 s11, s10, 16384
    s_add_u32 m0, s8, 0
    s_nop 0
    buffer_load_dwordx4 v12, s[48:51], s10 offen lds
    buffer_load_dwordx4 v13, s[48:51], s10 offen offset:1024 lds
    s_add_u32 m0, s8, 2048
    s_nop 0
    buffer_load_dwordx4 v12, s[48:51], s11 offen lds
    buffer_load_dwordx4 v13, s[48:51], s11 offen offset:1024 lds
    s_branch L_A
L_G:
    s_mov_b32 s62, s5
    v_bfe_u32 v14, v0, 4, 2
    v_and_b32 v15, 7, v0
    v_xor_b32 v14, v14, v15
    v_lshlrev_b32 v8, 4, v14
    v_lshrrev_b32 v14, 3, v0
    s_sub_u32 s6, s3, 4
    s_add_u32 s12, s62, s6
    s_and_b32 s12, s12, 3
    s_lshl_b32 s7, s4, 2
    s_add_u32 s7, s7, s12
    s_lshl_b32 s7, s7, 4
    v_add_u32 v14, s7, v14
    v_lshl_add_u32 v9, v14, 10, v8
    v_xor_b32 v10, 64, v9
    v_add_u32 v10, 7168, v10
    s_lshl_b32 s10, s12, 11
    s_lshl_b32 s11, s15, 7
    s_lshl_b32 s9, s15, 11
    s_setprio 2
    s_cmp_lg_u32 s6, 0
    s_cbranch_scc1 L_G123
    s_setprio 3
    s_and_b32 s7, s62, 3
    s_cmp_ge_u32 s62, 4
    s_cselect_b32 s8, 8, 9
    s_cselect_b32 s13, 9, 8
    s_cselect_b32 s60, 1024, 0
    s_and_b32 s61, s7, 1
    s_lshl_b32 s61, s61, s13
    s_add_u32 s60, s60, s61
    s_lshl_b32 s61, s4, 1
    s_lshr_b32 s13, s7, 1
    s_add_u32 s61, s61, s13
    s_mul_i32 s61, s61, 2304
    s_add_u32 s60, s60, s61
    v_bfe_u32 v15, v0, 4, 1
    v_lshlrev_b32 v15, s8, v15
    v_and_b32 v24, 15, v0
    v_lshl_add_u32 v23, v24, 4, v15
    v_cmp_gt_u32 vcc, 32, v0
    v_mov_b32 v36, 0x3f803f80
    s_sub_u32 s13, s61, s60
    s_add_u32 s13, s13, 2048
    v_mov_b32 v37, s13
    v_cndmask_b32 v38, v37, v23, vcc
    v_cndmask_b32 v32, v36, -1, vcc
    v_cndmask_b32 v33, v36, -1, vcc
    v_cndmask_b32 v34, v36, -1, vcc
    v_cndmask_b32 v35, v36, -1, vcc
    s_lshr_b32 s8, s62, 2
    s_lshl_b32 s8, s8, 1
    s_and_b32 s7, s7, 1
    s_add_u32 s8, s8, s7
    s_lshl_b32 s8, s8, 2
    s_add_u32 s61, s61, s8
    s_mov_b32 s8, 180224
    s_waitcnt lgkmcnt(0)
    s_mov_b32 s68, s42
    s_mov_b32 s69, s43
    s_mov_b32 s70, 0x940000
    s_mov_b32 s71, 0x20000
    buffer_load_dword v40, off, s[68:71], s8 sc1
    buffer_store_dwordx4 v[32:35], v38, s[68:71], s60 offen sc1
    s_mov_b32 s44, s16
    s_mov_b32 s45, s17
    s_mov_b32 s46, 0x200000
    s_mov_b32 s47, 0x20000
    s_cmp_ge_u32 s62, 4
    s_cselect_b32 s52, s22, s20
    s_cselect_b32 s53, s23, s21
    s_mov_b32 s54, 16384
    s_mov_b32 m0, 135168
    s_mov_b32 s55, 0x20000
    buffer_load_dwordx4 v2, s[52:55], s9 offen offset:0 lds
    buffer_load_dwordx4 v2, s[52:55], s9 offen offset:1024 lds
    s_add_u32 m0, s10, 0
    s_nop 0
    buffer_load_dwordx4 v9, s[44:47], s11 offen nt lds
    buffer_load_dwordx4 v10, s[44:47], s11 offen offset:1024 nt lds
    s_add_u32 m0, s10, 8192
    s_add_u32 s11, s11, 128
    s_and_b32 s11, s11, 0x380
    buffer_load_dwordx4 v9, s[44:47], s11 offen nt lds
    buffer_load_dwordx4 v10, s[44:47], s11 offen offset:1024 nt lds
    s_add_u32 m0, s10, 16384
    s_add_u32 s11, s11, 128
    s_and_b32 s11, s11, 0x380
    buffer_load_dwordx4 v9, s[44:47], s11 offen nt lds
    buffer_load_dwordx4 v10, s[44:47], s11 offen offset:1024 nt lds
    s_add_u32 m0, s10, 24576
    s_add_u32 s11, s11, 128
    s_and_b32 s11, s11, 0x380
    buffer_load_dwordx4 v9, s[44:47], s11 offen nt lds
    buffer_load_dwordx4 v10, s[44:47], s11 offen offset:1024 nt lds
    s_add_u32 m0, s10, 32768
    s_add_u32 s11, s11, 128
    s_and_b32 s11, s11, 0x380
    buffer_load_dwordx4 v9, s[44:47], s11 offen nt lds
    buffer_load_dwordx4 v10, s[44:47], s11 offen offset:1024 nt lds
    s_add_u32 m0, s10, 40960
    s_add_u32 s11, s11, 128
    s_and_b32 s11, s11, 0x380
    buffer_load_dwordx4 v9, s[44:47], s11 offen nt lds
    buffer_load_dwordx4 v10, s[44:47], s11 offen offset:1024 nt lds
    s_add_u32 m0, s10, 49152
    s_add_u32 s11, s11, 128
    s_and_b32 s11, s11, 0x380
    buffer_load_dwordx4 v9, s[44:47], s11 offen nt lds
    buffer_load_dwordx4 v10, s[44:47], s11 offen offset:1024 nt lds
    s_add_u32 m0, s10, 57344
    s_add_u32 s11, s11, 128
    s_and_b32 s11, s11, 0x380
    buffer_load_dwordx4 v9, s[44:47], s11 offen nt lds
    buffer_load_dwordx4 v10, s[44:47], s11 offen offset:1024 nt lds
    v_mov_b32 v36, 0
    v_mov_b32 v37, 0
    v_mov_b32 v38, 0
    v_mov_b32 v39, 0
    v_mov_b32 v14, 151808
    ds_write_b128 v14, v[36:39]
    ds_write_b128 v14, v[36:39] offset:16
    ds_write_b128 v14, v[36:39] offset:32
    s_waitcnt vmcnt(18)
    v_add_u32 v40, 0x9e3779b9, v40
    s_mov_b64 exec, 1
    buffer_store_dword v40, off, s[68:71], s61 offset:2176 sc1
    ds_write_b32 v14, v40 offset:24
    s_mov_b64 exec, -1
    s_mov_b32 m0, 137216
    s_add_u32 s9, s9, 2048
    s_and_b32 s9, s9, 0x3fff
    buffer_load_dwordx4 v2, s[52:55], s9 offen offset:0 lds
    buffer_load_dwordx4 v2, s[52:55], s9 offen offset:1024 lds
    s_mov_b32 s64, s36
    s_mov_b32 s65, s37
    s_mov_b32 s66, 0x400
    s_mov_b32 s67, 0x20000
    s_lshl_b32 s8, s15, 7
    v_add_u32 v14, s8, v2
    s_mov_b32 m0, 152576
    v_and_b32 v14, 0x3ff, v14
    buffer_load_dwordx4 v14, s[64:67], 0 offen lds
    s_mov_b32 m0, 139264
    s_add_u32 s9, s9, 2048
    s_and_b32 s9, s9, 0x3fff
    buffer_load_dwordx4 v2, s[52:55], s9 offen offset:0 lds
    buffer_load_dwordx4 v2, s[52:55], s9 offen offset:1024 lds
    s_mov_b32 m0, 141312
    s_add_u32 s9, s9, 2048
    s_and_b32 s9, s9, 0x3fff
    buffer_load_dwordx4 v2, s[52:55], s9 offen offset:0 lds
    buffer_load_dwordx4 v2, s[52:55], s9 offen offset:1024 lds
    s_mov_b32 m0, 143360
    s_add_u32 s9, s9, 2048
    s_and_b32 s9, s9, 0x3fff
    buffer_load_dwordx4 v2, s[52:55], s9 offen offset:0 lds
    buffer_load_dwordx4 v2, s[52:55], s9 offen offset:1024 lds
    s_mov_b32 m0, 145408
    s_add_u32 s9, s9, 2048
    s_and_b32 s9, s9, 0x3fff
    buffer_load_dwordx4 v2, s[52:55], s9 offen offset:0 lds
    buffer_load_dwordx4 v2, s[52:55], s9 offen offset:1024 lds
    s_mov_b32 m0, 147456
    s_add_u32 s9, s9, 2048
    s_and_b32 s9, s9, 0x3fff
    buffer_load_dwordx4 v2, s[52:55], s9 offen offset:0 lds
    buffer_load_dwordx4 v2, s[52:55], s9 offen offset:1024 lds
    s_mov_b32 m0, 149504
    s_add_u32 s9, s9, 2048
    s_and_b32 s9, s9, 0x3fff
    buffer_load_dwordx4 v2, s[52:55], s9 offen offset:0 lds
    buffer_load_dwordx4 v2, s[52:55], s9 offen offset:1024 lds
    s_waitcnt lgkmcnt(0)
    s_barrier
    v_bfe_u32 v14, v0, 1, 3
    v_lshrrev_b32 v15, 4, v0
    v_xor_b32 v14, v14, v15
    v_and_b32 v24, 15, v0
    s_lshl_b32 s7, s12, 4
    v_add_u32 v25, s7, v24
    v_lshlrev_b32 v25, 7, v25
    v_lshl_add_u32 v20, v14, 4, v25
    v_xor_b32 v21, 64, v20
    v_bfe_u32 v14, v0, 2, 2
    v_lshl_add_u32 v14, v15, 3, v14
    v_lshlrev_b32 v22, 5, v14
    v_and_b32 v14, 3, v0
    v_lshl_add_u32 v22, v14, 3, v22
    v_add_u32 v22, 135168, v22
    s_mov_b32 s99, 8000
    v_mov_b32 v34, 0
    v_mov_b32 v35, 0
    v_mov_b32 v14, 151808
    v_mov_b32 v15, 1
    s_cmp_ge_u32 s62, 4
    s_cbranch_scc1 L_G0_V
    s_waitcnt vmcnt(30)
    ds_read_b64_tr_b16 v[64:65], v22 offset:0
    ds_read_b64_tr_b16 v[66:67], v22 offset:128
    ds_read_b128 v[68:71], v20 offset:0
    ds_read_b64_tr_b16 v[72:73], v22 offset:1024
    ds_read_b64_tr_b16 v[74:75], v22 offset:1152
    ds_read_b128 v[76:79], v21 offset:0
    s_waitcnt vmcnt(14)
    ds_read_b64_tr_b16 v[80:81], v22 offset:2048
    ds_read_b64_tr_b16 v[82:83], v22 offset:2176
    ds_read_b128 v[84:87], v20 offset:8192
    s_waitcnt vmcnt(13)
    ds_read_b64_tr_b16 v[88:89], v22 offset:3072
    ds_read_b64_tr_b16 v[90:91], v22 offset:3200
    ds_read_b128 v[92:95], v21 offset:8192
    s_waitcnt lgkmcnt(9)
    v_mfma_f32_16x16x32_bf16 v[28:31], v[64:67], v[68:71], 0
    s_waitcnt vmcnt(11)
    s_mov_b64 exec, 1
    ds_add_u32 v14, v15 offset:0
    s_mov_b64 exec, -1
    ds_read_b64_tr_b16 v[64:65], v22 offset:4096
    ds_read_b64_tr_b16 v[66:67], v22 offset:4224
    ds_read_b128 v[68:71], v20 offset:16384
    s_waitcnt lgkmcnt(10)
    v_mfma_f32_16x16x32_bf16 v[28:31], v[72:75], v[76:79], v[28:31]
    s_waitcnt vmcnt(10)
    ds_read_b64_tr_b16 v[72:73], v22 offset:5120
    ds_read_b64_tr_b16 v[74:75], v22 offset:5248
    ds_read_b128 v[76:79], v21 offset:16384
    s_waitcnt lgkmcnt(10)
    v_mfma_f32_16x16x32_bf16 v[28:31], v[80:83], v[84:87], v[28:31]
    s_waitcnt vmcnt(9)
    ds_read_b64_tr_b16 v[80:81], v22 offset:6144
    ds_read_b64_tr_b16 v[82:83], v22 offset:6272
    ds_read_b128 v[84:87], v20 offset:24576
    s_waitcnt lgkmcnt(10)
    v_mfma_f32_16x16x32_bf16 v[28:31], v[88:91], v[92:95], v[28:31]
    s_waitcnt vmcnt(8)
    ds_read_b64_tr_b16 v[88:89], v22 offset:7168
    ds_read_b64_tr_b16 v[90:91], v22 offset:7296
    ds_read_b128 v[92:95], v21 offset:24576
    s_waitcnt lgkmcnt(9)
    v_mfma_f32_16x16x32_bf16 v[28:31], v[64:67], v[68:71], v[28:31]
    s_waitcnt vmcnt(7)
    ds_read_b64_tr_b16 v[64:65], v22 offset:8192
    ds_read_b64_tr_b16 v[66:67], v22 offset:8320
    ds_read_b128 v[68:71], v20 offset:32768
    s_waitcnt lgkmcnt(9)
    v_mfma_f32_16x16x32_bf16 v[28:31], v[72:75], v[76:79], v[28:31]
    s_waitcnt vmcnt(6)
    ds_read_b64_tr_b16 v[72:73], v22 offset:9216
    ds_read_b64_tr_b16 v[74:75], v22 offset:9344
    ds_read_b128 v[76:79], v21 offset:32768
    s_waitcnt lgkmcnt(9)
    v_mfma_f32_16x16x32_bf16 v[28:31], v[80:83], v[84:87], v[28:31]
    s_waitcnt vmcnt(5)
    ds_read_b64_tr_b16 v[80:81], v22 offset:10240
    ds_read_b64_tr_b16 v[82:83], v22 offset:10368
    ds_read_b128 v[84:87], v20 offset:40960
    s_waitcnt lgkmcnt(9)
    v_mfma_f32_16x16x32_bf16 v[28:31], v[88:91], v[92:95], v[28:31]
    s_waitcnt vmcnt(4)
    ds_read_b64_tr_b16 v[88:89], v22 offset:11264
    ds_read_b64_tr_b16 v[90:91], v22 offset:11392
    ds_read_b128 v[92:95], v21 offset:40960
    s_waitcnt lgkmcnt(9)
    v_mfma_f32_16x16x32_bf16 v[28:31], v[64:67], v[68:71], v[28:31]
    s_waitcnt vmcnt(3)
    ds_read_b64_tr_b16 v[64:65], v22 offset:12288
    ds_read_b64_tr_b16 v[66:67], v22 offset:12416
    ds_read_b128 v[68:71], v20 offset:49152
    s_waitcnt lgkmcnt(9)
    v_mfma_f32_16x16x32_bf16 v[28:31], v[72:75], v[76:79], v[28:31]
    s_waitcnt vmcnt(2)
    ds_read_b64_tr_b16 v[72:73], v22 offset:13312
    ds_read_b64_tr_b16 v[74:75], v22 offset:13440
    ds_read_b128 v[76:79], v21 offset:49152
    s_waitcnt lgkmcnt(9)
    v_mfma_f32_16x16x32_bf16 v[28:31], v[80:83], v[84:87], v[28:31]
    s_waitcnt vmcnt(1)
    ds_read_b64_tr_b16 v[80:81], v22 offset:14336
    ds_read_b64_tr_b16 v[82:83], v22 offset:14464
    ds_read_b128 v[84:87], v20 offset:57344
    s_waitcnt lgkmcnt(9)
    v_mfma_f32_16x16x32_bf16 v[28:31], v[88:91], v[92:95], v[28:31]
    s_waitcnt vmcnt(0)
    ds_read_b64_tr_b16 v[88:89], v22 offset:15360
    ds_read_b64_tr_b16 v[90:91], v22 offset:15488
    ds_read_b128 v[92:95], v21 offset:57344
    s_waitcnt lgkmcnt(9)
    v_mfma_f32_16x16x32_bf16 v[28:31], v[64:67], v[68:71], v[28:31]
    s_waitcnt lgkmcnt(6)
    v_mfma_f32_16x16x32_bf16 v[28:31], v[72:75], v[76:79], v[28:31]
    s_waitcnt lgkmcnt(3)
    v_mfma_f32_16x16x32_bf16 v[28:31], v[80:83], v[84:87], v[28:31]
    s_waitcnt lgkmcnt(0)
    v_mfma_f32_16x16x32_bf16 v[28:31], v[88:91], v[92:95], v[28:31]
    s_branch L_G0_pub
L_G0_V:
    s_waitcnt vmcnt(30)
    ds_read_b64_tr_b16 v[64:65], v22 offset:0
    ds_read_b64_tr_b16 v[66:67], v22 offset:128
    ds_read_b128 v[68:71], v20 offset:0
    ds_read_b64_tr_b16 v[72:73], v22 offset:1024
    ds_read_b64_tr_b16 v[74:75], v22 offset:1152
    ds_read_b128 v[76:79], v21 offset:0
    s_waitcnt vmcnt(14)
    ds_read_b64_tr_b16 v[80:81], v22 offset:2048
    ds_read_b64_tr_b16 v[82:83], v22 offset:2176
    ds_read_b128 v[84:87], v20 offset:8192
    s_waitcnt vmcnt(13)
    ds_read_b64_tr_b16 v[88:89], v22 offset:3072
    ds_read_b64_tr_b16 v[90:91], v22 offset:3200
    ds_read_b128 v[92:95], v21 offset:8192
    s_waitcnt lgkmcnt(9)
    v_mfma_f32_16x16x32_bf16 v[28:31], v[68:71], v[64:67], 0
    s_waitcnt vmcnt(11)
    s_mov_b64 exec, 1
    ds_add_u32 v14, v15 offset:0
    s_mov_b64 exec, -1
    ds_read_b64_tr_b16 v[64:65], v22 offset:4096
    ds_read_b64_tr_b16 v[66:67], v22 offset:4224
    ds_read_b128 v[68:71], v20 offset:16384
    s_waitcnt lgkmcnt(10)
    v_mfma_f32_16x16x32_bf16 v[28:31], v[76:79], v[72:75], v[28:31]
    s_waitcnt vmcnt(10)
    ds_read_b64_tr_b16 v[72:73], v22 offset:5120
    ds_read_b64_tr_b16 v[74:75], v22 offset:5248
    ds_read_b128 v[76:79], v21 offset:16384
    s_waitcnt lgkmcnt(10)
    v_mfma_f32_16x16x32_bf16 v[28:31], v[84:87], v[80:83], v[28:31]
    s_waitcnt vmcnt(9)
    ds_read_b64_tr_b16 v[80:81], v22 offset:6144
    ds_read_b64_tr_b16 v[82:83], v22 offset:6272
    ds_read_b128 v[84:87], v20 offset:24576
    s_waitcnt lgkmcnt(10)
    v_mfma_f32_16x16x32_bf16 v[28:31], v[92:95], v[88:91], v[28:31]
    s_waitcnt vmcnt(8)
    ds_read_b64_tr_b16 v[88:89], v22 offset:7168
    ds_read_b64_tr_b16 v[90:91], v22 offset:7296
    ds_read_b128 v[92:95], v21 offset:24576
    s_waitcnt lgkmcnt(9)
    v_mfma_f32_16x16x32_bf16 v[28:31], v[68:71], v[64:67], v[28:31]
    s_waitcnt vmcnt(7)
    ds_read_b64_tr_b16 v[64:65], v22 offset:8192
    ds_read_b64_tr_b16 v[66:67], v22 offset:8320
    ds_read_b128 v[68:71], v20 offset:32768
    s_waitcnt lgkmcnt(9)
    v_mfma_f32_16x16x32_bf16 v[28:31], v[76:79], v[72:75], v[28:31]
    s_waitcnt vmcnt(6)
    ds_read_b64_tr_b16 v[72:73], v22 offset:9216
    ds_read_b64_tr_b16 v[74:75], v22 offset:9344
    ds_read_b128 v[76:79], v21 offset:32768
    s_waitcnt lgkmcnt(9)
    v_mfma_f32_16x16x32_bf16 v[28:31], v[84:87], v[80:83], v[28:31]
    s_waitcnt vmcnt(5)
    ds_read_b64_tr_b16 v[80:81], v22 offset:10240
    ds_read_b64_tr_b16 v[82:83], v22 offset:10368
    ds_read_b128 v[84:87], v20 offset:40960
    s_waitcnt lgkmcnt(9)
    v_mfma_f32_16x16x32_bf16 v[28:31], v[92:95], v[88:91], v[28:31]
    s_waitcnt vmcnt(4)
    ds_read_b64_tr_b16 v[88:89], v22 offset:11264
    ds_read_b64_tr_b16 v[90:91], v22 offset:11392
    ds_read_b128 v[92:95], v21 offset:40960
    s_waitcnt lgkmcnt(9)
    v_mfma_f32_16x16x32_bf16 v[28:31], v[68:71], v[64:67], v[28:31]
    s_waitcnt vmcnt(3)
    ds_read_b64_tr_b16 v[64:65], v22 offset:12288
    ds_read_b64_tr_b16 v[66:67], v22 offset:12416
    ds_read_b128 v[68:71], v20 offset:49152
    s_waitcnt lgkmcnt(9)
    v_mfma_f32_16x16x32_bf16 v[28:31], v[76:79], v[72:75], v[28:31]
    s_waitcnt vmcnt(2)
    ds_read_b64_tr_b16 v[72:73], v22 offset:13312
    ds_read_b64_tr_b16 v[74:75], v22 offset:13440
    ds_read_b128 v[76:79], v21 offset:49152
    s_waitcnt lgkmcnt(9)
    v_mfma_f32_16x16x32_bf16 v[28:31], v[84:87], v[80:83], v[28:31]
    s_waitcnt vmcnt(1)
    ds_read_b64_tr_b16 v[80:81], v22 offset:14336
    ds_read_b64_tr_b16 v[82:83], v22 offset:14464
    ds_read_b128 v[84:87], v20 offset:57344
    s_waitcnt lgkmcnt(9)
    v_mfma_f32_16x16x32_bf16 v[28:31], v[92:95], v[88:91], v[28:31]
    s_waitcnt vmcnt(0)
    ds_read_b64_tr_b16 v[88:89], v22 offset:15360
    ds_read_b64_tr_b16 v[90:91], v22 offset:15488
    ds_read_b128 v[92:95], v21 offset:57344
    s_waitcnt lgkmcnt(9)
    v_mfma_f32_16x16x32_bf16 v[28:31], v[68:71], v[64:67], v[28:31]
    s_waitcnt lgkmcnt(6)
    v_mfma_f32_16x16x32_bf16 v[28:31], v[76:79], v[72:75], v[28:31]
    s_waitcnt lgkmcnt(3)
    v_mfma_f32_16x16x32_bf16 v[28:31], v[84:87], v[80:83], v[28:31]
    s_waitcnt lgkmcnt(0)
    v_mfma_f32_16x16x32_bf16 v[28:31], v[92:95], v[88:91], v[28:31]
L_G0_pub:
    s_mov_b64 exec, 1
    ds_add_u32 v14, v15 offset:12
    s_mov_b64 exec, -1
    s_cmp_ge_u32 s62, 4
    s_cselect_b32 s8, 1.0, 0x3eb8aa3b
    s_nop 2
    v_mul_f32 v28, s8, v28
    v_mul_f32 v29, s8, v29
    v_mul_f32 v30, s8, v30
    v_mul_f32 v31, s8, v31
    v_cvt_pk_bf16_f32 v32, v28, v29
    v_cvt_pk_bf16_f32 v33, v30, v31
    v_min_u32 v32, -2, v32
    s_nop 0
    v_permlane32_swap_b32 v33, v35
    v_permlane32_swap_b32 v32, v34
    s_mov_b32 exec_hi, 0
    buffer_store_dwordx4 v[32:35], v23, s[68:71], s60 offen sc1
    s_mov_b32 exec_hi, -1
    s_mov_b32 s56, s28
    s_mov_b32 s57, s29
    s_mov_b32 s58, 0x1c0000
    s_mov_b32 s59, 0x20000
    s_mov_b32 s60, s30
    s_mov_b32 s61, s31
    s_mov_b32 s62, 0xe00
    s_mov_b32 s63, 0x20000
    v_lshrrev_b32 v14, 3, v0
    v_mul_u32_u24 v4, 3584, v14
    v_bfe_u32 v14, v0, 4, 1
    v_lshlrev_b32 v14, 2, v14
    v_xor_b32 v14, v14, v0
    v_and_b32 v14, 7, v14
    v_lshl_add_u32 v4, v14, 4, v4
    v_add_u32 v5, 27648, v4
    v_lshrrev_b32 v14, 3, v0
    v_mul_u32_u24 v6, 1024, v14
    v_bfe_u32 v14, v0, 4, 1
    v_lshlrev_b32 v14, 2, v14
    v_xor_b32 v14, v14, v0
    v_and_b32 v14, 7, v14
    v_lshl_add_u32 v6, v14, 4, v6
    v_add_u32 v7, 7168, v6
    s_and_b32 s12, s5, 3
    s_mul_i32 s12, s12, 7
    s_lshr_b32 s9, s5, 2
    s_lshl_b32 s9, s9, 2
    s_add_u32 s13, s9, s6
    s_add_u32 s12, s12, s13
    s_lshl_b32 s12, s12, 7
    s_add_u32 s77, s12, 1835008
    s_mul_i32 s76, s15, 229376
    s_add_u32 s76, s76, s12
    v_lshlrev_b32 v14, 1, v0
    v_cmp_gt_u32 vcc, 32, v0
    v_mov_b32 v15, 0x40000000
    v_mov_b32 v12, 151808
    v_cndmask_b32 v11, v15, v14, vcc
    v_mov_b32 v15, 0x3f80
    v_cndmask_b32 v28, 0, v15, vcc
    v_mov_b32 v21, 0
    v_mov_b32 v22, 0
    v_mov_b32 v23, 0
    v_mov_b32 v25, 0
    v_mov_b32 v26, 0
    v_mov_b32 v27, 0
    v_mov_b32 v29, 0
    v_mov_b32 v30, 0
    v_mov_b32 v31, 0
    v_bfe_u32 v14, v0, 1, 3
    v_lshrrev_b32 v15, 5, v0
    v_xor_b32 v14, v14, v15
    v_and_b32 v15, 31, v0
    v_lshlrev_b32 v15, 7, v15
    v_xor_b32 v16, 0, v14
    v_lshl_add_u32 v16, v16, 4, v15
    v_xor_b32 v17, 2, v14
    v_lshl_add_u32 v17, v17, 4, v15
    v_xor_b32 v18, 4, v14
    v_lshl_add_u32 v18, v18, 4, v15
    v_xor_b32 v19, 6, v14
    v_lshl_add_u32 v19, v19, 4, v15
    v_lshrrev_b32 v14, 5, v0
    v_mul_u32_u24 v14, 8, v14
    v_bfe_u32 v15, v0, 2, 2
    v_add_u32 v14, v14, v15
    v_lshlrev_b32 v224, 7, v14
    v_and_b32 v15, 3, v0
    v_lshl_add_u32 v224, v15, 3, v224
    v_bfe_u32 v15, v0, 4, 1
    v_lshl_add_u32 v224, v15, 5, v224
    v_bfe_u32 v15, v0, 3, 1
    v_lshl_add_u32 v224, v15, 6, v224
    v_lshrrev_b32 v14, 5, v0
    v_mul_u32_u24 v14, 4, v14
    v_bfe_u32 v15, v0, 2, 2
    v_add_u32 v14, v14, v15
    v_lshlrev_b32 v226, 7, v14
    v_and_b32 v15, 3, v0
    v_lshl_add_u32 v226, v15, 3, v226
    v_bfe_u32 v15, v0, 4, 1
    v_lshl_add_u32 v226, v15, 5, v226
    v_bfe_u32 v15, v0, 3, 1
    v_lshl_add_u32 v226, v15, 6, v226
    s_lshl_b32 s8, s6, 11
    s_add_u32 s8, s8, 135168
    v_add_u32 v3, s8, v2
    v_add_u32 v228, s8, v224
    s_mul_i32 s14, s6, 17408
    s_add_u32 s14, s14, 65536
    v_add_u32 v224, s14, v224
    v_add_u32 v226, s14, v226
    v_xor_b32 v225, 64, v224
    v_xor_b32 v227, 64, v226
    v_xor_b32 v229, 64, v228
    v_mov_b32 v8, 1
    s_setprio 2
    s_branch L_G_ffn1
L_A:
    s_mov_b32 s68, s42
    s_mov_b32 s69, s43
    s_mov_b32 s70, 0x940000
    s_mov_b32 s71, 0x20000
    v_bfe_u32 v14, v0, 1, 3
    v_lshrrev_b32 v15, 5, v0
    v_xor_b32 v14, v14, v15
    v_and_b32 v15, 31, v0
    v_lshlrev_b32 v15, 7, v15
    v_xor_b32 v88, 0, v14
    v_lshl_add_u32 v88, v88, 4, v15
    v_xor_b32 v89, 2, v14
    v_lshl_add_u32 v89, v89, 4, v15
    v_xor_b32 v90, 4, v14
    v_lshl_add_u32 v90, v90, 4, v15
    v_xor_b32 v91, 6, v14
    v_lshl_add_u32 v91, v91, 4, v15
    v_lshrrev_b32 v14, 5, v0
    v_mul_u32_u24 v14, 8, v14
    v_bfe_u32 v15, v0, 2, 2
    v_add_u32 v14, v14, v15
    v_lshlrev_b32 v92, 7, v14
    v_and_b32 v15, 3, v0
    v_lshl_add_u32 v92, v15, 3, v92
    v_bfe_u32 v15, v0, 4, 1
    v_lshl_add_u32 v92, v15, 5, v92
    v_bfe_u32 v15, v0, 3, 1
    v_lshl_add_u32 v92, v15, 6, v92
    s_and_b32 s6, s3, 1
    s_lshr_b32 s7, s3, 1
    s_lshl_b32 s12, s6, 6
    v_xor_b32 v92, s12, v92
    v_add_u32 v92, 65536, v92
    s_lshl_b32 s12, s7, 12
    v_add_u32 v88, s12, v88
    v_add_u32 v89, s12, v89
    v_add_u32 v90, s12, v90
    v_add_u32 v91, s12, v91
    v_and_b32 v6, 15, v0
    v_lshrrev_b32 v7, 5, v0
    v_lshlrev_b32 v7, 8, v7
    v_lshl_add_u32 v3, v6, 4, v7
    v_add_u32 v1, 512, v3
    v_and_b32 v6, 27, v0
    v_cmp_eq_u32 vcc, 16, v6
    v_mov_b32 v7, 0x40000000
    v_mov_b32 v14, 1024
    v_cndmask_b32 v7, v7, v14, vcc
    v_and_b32 v6, 16, v0
    v_cmp_eq_u32 vcc, 0, v6
    s_mul_i32 s66, s3, 36864
    s_add_u32 s62, s66, 4608
    v_cndmask_b32 v3, v7, v3, vcc
    v_cndmask_b32 v1, v7, v1, vcc
    s_mov_b32 s76, s42
    s_mov_b32 s77, s43
    s_mov_b32 s78, 0x940000
    s_mov_b32 s79, 0x20000
    s_add_u32 s78, s66, 36864
    s_mov_b32 s65, 8000
    v_mov_b32 v93, 151808
    v_mov_b32 v100, 0
    v_mov_b32 v101, 0
    v_mov_b32 v102, 0
    v_mov_b32 v103, 0
    v_mov_b32 v124, 0
    v_mov_b32 v125, 0
    v_mov_b32 v126, 0
    v_mov_b32 v127, 0
    v_mov_b32 v128, 0
    v_mov_b32 v129, 0
    v_mov_b32 v130, 0
    v_mov_b32 v131, 0
    v_mov_b32 v132, 0
    v_mov_b32 v133, 0
    v_mov_b32 v134, 0
    v_mov_b32 v135, 0
    v_mov_b32 v136, 0
    v_mov_b32 v137, 0
    v_mov_b32 v138, 0
    v_mov_b32 v139, 0
    v_mov_b32 v140, 0
    v_mov_b32 v141, 0
    v_mov_b32 v142, 0
    v_mov_b32 v143, 0
    v_mov_b32 v144, 0
    v_mov_b32 v145, 0
    v_mov_b32 v146, 0
    v_mov_b32 v147, 0
    v_mov_b32 v148, 0
    v_mov_b32 v149, 0
    v_mov_b32 v150, 0
    v_mov_b32 v151, 0
    v_mov_b32 v152, 0
    v_mov_b32 v153, 0
    v_mov_b32 v154, 0
    v_mov_b32 v155, 0
    v_mov_b32 v156, 0
    v_mov_b32 v157, 0
    v_mov_b32 v158, 0
    v_mov_b32 v159, 0
    v_mov_b32 v160, 0
    v_mov_b32 v161, 0
    v_mov_b32 v162, 0
    v_mov_b32 v163, 0
    v_mov_b32 v164, 0
    v_mov_b32 v165, 0
    v_mov_b32 v166, 0
    v_mov_b32 v167, 0
    v_mov_b32 v168, 0
    v_mov_b32 v169, 0
    v_mov_b32 v170, 0
    v_mov_b32 v171, 0
    v_mov_b32 v172, 0
    v_mov_b32 v173, 0
    v_mov_b32 v174, 0
    v_mov_b32 v175, 0
    v_mov_b32 v176, 0
    v_mov_b32 v177, 0
    v_mov_b32 v178, 0
    v_mov_b32 v179, 0
    v_mov_b32 v180, 0
    v_mov_b32 v181, 0
    v_mov_b32 v182, 0
    v_mov_b32 v183, 0
    v_mov_b32 v184, 0
    v_mov_b32 v185, 0
    v_mov_b32 v186, 0
    v_mov_b32 v187, 0
    v_mov_b32 v188, 0
    v_mov_b32 v189, 0
    v_mov_b32 v190, 0
    v_mov_b32 v191, 0
    v_mov_b32 v192, 0
    v_mov_b32 v193, 0
    v_mov_b32 v194, 0
    v_mov_b32 v195, 0
    v_mov_b32 v196, 0
    v_mov_b32 v197, 0
    v_mov_b32 v198, 0
    v_mov_b32 v199, 0
    v_mov_b32 v200, 0
    v_mov_b32 v201, 0
    v_mov_b32 v202, 0
    v_mov_b32 v203, 0
    v_mov_b32 v204, 0
    v_mov_b32 v205, 0
    v_mov_b32 v206, 0
    v_mov_b32 v207, 0
    v_mov_b32 v208, 0
    v_mov_b32 v209, 0
    v_mov_b32 v210, 0
    v_mov_b32 v211, 0
    v_mov_b32 v212, 0
    v_mov_b32 v213, 0
    v_mov_b32 v214, 0
    v_mov_b32 v215, 0
    v_mov_b32 v216, 0
    v_mov_b32 v217, 0
    v_mov_b32 v218, 0
    v_mov_b32 v219, 0
    v_mov_b32 v220, 0
    v_mov_b32 v221, 0
    v_mov_b32 v222, 0
    v_mov_b32 v223, 0
    v_mov_b32 v224, 0
    v_mov_b32 v225, 0
    v_mov_b32 v226, 0
    v_mov_b32 v227, 0
    v_mov_b32 v228, 0
    v_mov_b32 v229, 0
    v_mov_b32 v230, 0
    v_mov_b32 v231, 0
    v_mov_b32 v232, 0
    v_mov_b32 v233, 0
    v_mov_b32 v234, 0
    v_mov_b32 v235, 0
    v_mov_b32 v236, 0
    v_mov_b32 v237, 0
    v_mov_b32 v238, 0
    v_mov_b32 v239, 0
    v_mov_b32 v240, 0
    v_mov_b32 v241, 0
    v_mov_b32 v242, 0
    v_mov_b32 v243, 0
    v_mov_b32 v244, 0
    v_mov_b32 v245, 0
    v_mov_b32 v246, 0
    v_mov_b32 v247, 0
    v_mov_b32 v248, 0
    v_mov_b32 v249, 0
    v_mov_b32 v250, 0
    v_mov_b32 v251, 0
    v_mov_b32 v252, 0
    v_mov_b32 v253, 0
    v_mov_b32 v254, 0
    v_lshrrev_b32 v4, 2, v0
    v_mul_u32_u24 v4, 2304, v4
    v_and_b32 v5, 3, v0
    v_bfe_u32 v14, v0, 1, 1
    v_lshl_add_u32 v116, v14, 10, v4
    v_add_u32 v14, 8, v14
    v_and_b32 v15, 1, v0
    v_lshlrev_b32 v15, v14, v15
    v_add_u32 v116, v116, v15
    v_subrev_u32 v14, 4, v0
    v_cmp_gt_u32 vcc, 24, v14
    v_mov_b32 v15, 0x40000000
    s_nop 0
    v_cndmask_b32 v116, v15, v116, vcc
    v_lshl_add_u32 v4, v5, 2, v4
    v_add_u32 v4, 2176, v4
    s_lshl_b32 s8, s6, 12
    s_lshl_b32 s9, s7, 10
    s_add_u32 s8, s8, s9
    s_add_u32 s8, s8, 143360
    v_add_u32 v95, s8, v2
    s_mov_b32 s52, 0x3eb8aa3b
    s_add_u32 s8, s3, 1
    s_and_b32 s8, s8, 3
    s_lshl_b32 s8, s8, 11
    s_add_u32 s8, s8, 143360
    v_add_u32 v96, s8, v2
    s_add_u32 s8, s3, 2
    s_and_b32 s8, s8, 3
    s_lshl_b32 s8, s8, 11
    s_add_u32 s8, s8, 143360
    v_add_u32 v97, s8, v2
    s_add_u32 s8, s3, 3
    s_and_b32 s8, s8, 3
    s_lshl_b32 s8, s8, 11
    s_add_u32 s8, s8, 143360
    v_add_u32 v98, s8, v2
    s_add_u32 s8, s3, 4
    s_and_b32 s8, s8, 3
    s_lshl_b32 s8, s8, 11
    s_add_u32 s8, s8, 143360
    v_add_u32 v99, s8, v2
    s_lshl_b32 s53, s4, 5
    s_lshl_b32 s9, s5, 2
    s_add_u32 s53, s53, s9
    s_add_u32 s53, s53, s3
    s_lshl_b32 s53, s53, 11
    s_add_u32 s53, s53, 262144
    s_mov_b32 s80, 0x30800000
    s_mov_b32 s81, 0x71800000
    s_add_u32 s9, s3, 3
    s_and_b32 s9, s9, 3
    s_add_u32 s9, s9, 0
    s_mul_i32 s82, s9, 4608
    s_add_u32 s9, s3, 2
    s_and_b32 s9, s9, 3
    s_add_u32 s9, s9, 4
    s_mul_i32 s83, s9, 4608
    s_add_u32 s9, s3, 1
    s_and_b32 s9, s9, 3
    s_add_u32 s9, s9, 8
    s_mul_i32 s84, s9, 4608
    s_mul_i32 s67, s3, 4608
    s_barrier
    ds_read_b32 v6, v93 offset:24
    v_mov_b32 v7, 1
    s_waitcnt lgkmcnt(0)
    v_readfirstlane_b32 s59, v6
    s_waitcnt vmcnt(0)
    s_mov_b64 exec, 1
    ds_add_u32 v93, v7 offset:0
    s_mov_b64 exec, -1
    v_mov_b32 v255, 0
    s_setprio 1
L_k0:
    ds_read_b32 v6, v93 offset:0
    s_waitcnt lgkmcnt(0)
    v_readfirstlane_b32 s8, v6
    s_nop 0
    s_cmp_ge_u32 s8, 8
    s_cbranch_scc0 L_k0
    ds_read_b64_tr_b16 v[8:9], v92 offset:0
    ds_read_b64_tr_b16 v[10:11], v92 offset:512
    ds_read_b128 v[12:15], v88 offset:0
    ds_read_b64_tr_b16 v[16:17], v92 offset:2048
    ds_read_b64_tr_b16 v[18:19], v92 offset:2560
    ds_read_b128 v[20:23], v89 offset:0
    ds_read_b64_tr_b16 v[24:25], v92 offset:4096
    ds_read_b64_tr_b16 v[26:27], v92 offset:4608
    ds_read_b128 v[28:31], v90 offset:0
    ds_read_b64_tr_b16 v[32:33], v92 offset:6144
    ds_read_b64_tr_b16 v[34:35], v92 offset:6656
    ds_read_b128 v[36:39], v91 offset:0
    s_waitcnt lgkmcnt(9)
    v_mfma_f32_32x32x16_bf16 v[64:79], v[8:11], v[12:15], 0
    ds_read_b32 v6, v93 offset:4
    ds_read_b64_tr_b16 v[8:9], v92 offset:8192
    ds_read_b64_tr_b16 v[10:11], v92 offset:8704
    ds_read_b128 v[12:15], v88 offset:8192
    s_waitcnt lgkmcnt(10)
    v_mfma_f32_32x32x16_bf16 v[64:79], v[16:19], v[20:23], v[64:79]
    ds_read_b64_tr_b16 v[16:17], v92 offset:10240
    ds_read_b64_tr_b16 v[18:19], v92 offset:10752
    ds_read_b128 v[20:23], v89 offset:8192
    s_waitcnt lgkmcnt(10)
    v_mfma_f32_32x32x16_bf16 v[64:79], v[24:27], v[28:31], v[64:79]
    ds_read_b64_tr_b16 v[24:25], v92 offset:12288
    ds_read_b64_tr_b16 v[26:27], v92 offset:12800
    ds_read_b128 v[28:31], v90 offset:8192
    s_waitcnt lgkmcnt(10)
    v_mfma_f32_32x32x16_bf16 v[64:79], v[32:35], v[36:39], v[64:79]
    ds_read_b64_tr_b16 v[32:33], v92 offset:14336
    ds_read_b64_tr_b16 v[34:35], v92 offset:14848
    ds_read_b128 v[36:39], v91 offset:8192
    s_waitcnt lgkmcnt(9)
    v_mfma_f32_32x32x16_bf16 v[64:79], v[8:11], v[12:15], v[64:79]
    v_readfirstlane_b32 s8, v6
    s_nop 0
    s_cmp_ge_u32 s8, 3
    s_cbranch_scc0 L_k1
L_k1_ok:
    ds_read_b64_tr_b16 v[8:9], v92 offset:16384
    ds_read_b64_tr_b16 v[10:11], v92 offset:16896
    ds_read_b128 v[12:15], v88 offset:16384
    s_waitcnt lgkmcnt(9)
    v_mfma_f32_32x32x16_bf16 v[64:79], v[16:19], v[20:23], v[64:79]
    ds_read_b64_tr_b16 v[16:17], v92 offset:18432
    ds_read_b64_tr_b16 v[18:19], v92 offset:18944
    ds_read_b128 v[20:23], v89 offset:16384
    s_waitcnt lgkmcnt(9)
    v_mfma_f32_32x32x16_bf16 v[64:79], v[24:27], v[28:31], v[64:79]
    ds_read_b64_tr_b16 v[24:25], v92 offset:20480
    ds_read_b64_tr_b16 v[26:27], v92 offset:20992
    ds_read_b128 v[28:31], v90 offset:16384
    s_waitcnt lgkmcnt(9)
    v_mfma_f32_32x32x16_bf16 v[64:79], v[32:35], v[36:39], v[64:79]
    ds_read_b64_tr_b16 v[32:33], v92 offset:22528
    ds_read_b64_tr_b16 v[34:35], v92 offset:23040
    ds_read_b128 v[36:39], v91 offset:16384
    buffer_load_dword v5, v4, s[68:71], s66 offen sc1
    s_waitcnt lgkmcnt(9)
    v_mfma_f32_32x32x16_bf16 v[64:79], v[8:11], v[12:15], v[64:79]
    ds_read_b32 v6, v93 offset:8
    ds_read_b64_tr_b16 v[8:9], v92 offset:24576
    ds_read_b64_tr_b16 v[10:11], v92 offset:25088
    ds_read_b128 v[12:15], v88 offset:24576
    s_waitcnt lgkmcnt(10)
    v_mfma_f32_32x32x16_bf16 v[64:79], v[16:19], v[20:23], v[64:79]
    ds_read_b64_tr_b16 v[16:17], v92 offset:26624
    ds_read_b64_tr_b16 v[18:19], v92 offset:27136
    ds_read_b128 v[20:23], v89 offset:24576
    s_waitcnt lgkmcnt(10)
    v_mfma_f32_32x32x16_bf16 v[64:79], v[24:27], v[28:31], v[64:79]
    ds_read_b64_tr_b16 v[24:25], v92 offset:28672
    ds_read_b64_tr_b16 v[26:27], v92 offset:29184
    ds_read_b128 v[28:31], v90 offset:24576
    s_waitcnt lgkmcnt(10)
    v_mfma_f32_32x32x16_bf16 v[64:79], v[32:35], v[36:39], v[64:79]
    ds_read_b64_tr_b16 v[32:33], v92 offset:30720
    ds_read_b64_tr_b16 v[34:35], v92 offset:31232
    ds_read_b128 v[36:39], v91 offset:24576
    s_waitcnt lgkmcnt(9)
    v_mfma_f32_32x32x16_bf16 v[64:79], v[8:11], v[12:15], v[64:79]
    v_readfirstlane_b32 s8, v6
    s_nop 0
    s_cmp_ge_u32 s8, 3
    s_cbranch_scc0 L_k2
L_k2_ok:
    ds_read_b64_tr_b16 v[8:9], v92 offset:32768
    ds_read_b64_tr_b16 v[10:11], v92 offset:33280
    ds_read_b128 v[12:15], v88 offset:32768
    s_waitcnt lgkmcnt(9)
    v_mfma_f32_32x32x16_bf16 v[64:79], v[16:19], v[20:23], v[64:79]
    ds_read_b64_tr_b16 v[16:17], v92 offset:34816
    ds_read_b64_tr_b16 v[18:19], v92 offset:35328
    ds_read_b128 v[20:23], v89 offset:32768
    s_waitcnt lgkmcnt(9)
    v_mfma_f32_32x32x16_bf16 v[64:79], v[24:27], v[28:31], v[64:79]
    ds_read_b64_tr_b16 v[24:25], v92 offset:36864
    ds_read_b64_tr_b16 v[26:27], v92 offset:37376
    ds_read_b128 v[28:31], v90 offset:32768
    s_waitcnt lgkmcnt(9)
    v_mfma_f32_32x32x16_bf16 v[64:79], v[32:35], v[36:39], v[64:79]
    ds_read_b64_tr_b16 v[32:33], v92 offset:38912
    ds_read_b64_tr_b16 v[34:35], v92 offset:39424
    ds_read_b128 v[36:39], v91 offset:32768
    s_waitcnt lgkmcnt(9)
    v_mfma_f32_32x32x16_bf16 v[64:79], v[8:11], v[12:15], v[64:79]
    ds_read_b32 v6, v93 offset:12
    ds_read_b64_tr_b16 v[8:9], v92 offset:40960
    ds_read_b64_tr_b16 v[10:11], v92 offset:41472
    ds_read_b128 v[12:15], v88 offset:40960
    s_waitcnt lgkmcnt(10)
    v_mfma_f32_32x32x16_bf16 v[64:79], v[16:19], v[20:23], v[64:79]
    ds_read_b64_tr_b16 v[16:17], v92 offset:43008
    ds_read_b64_tr_b16 v[18:19], v92 offset:43520
    ds_read_b128 v[20:23], v89 offset:40960
    s_waitcnt lgkmcnt(10)
    v_mfma_f32_32x32x16_bf16 v[64:79], v[24:27], v[28:31], v[64:79]
    ds_read_b64_tr_b16 v[24:25], v92 offset:45056
    ds_read_b64_tr_b16 v[26:27], v92 offset:45568
    ds_read_b128 v[28:31], v90 offset:40960
    s_waitcnt lgkmcnt(10)
    v_mfma_f32_32x32x16_bf16 v[64:79], v[32:35], v[36:39], v[64:79]
    ds_read_b64_tr_b16 v[32:33], v92 offset:47104
    ds_read_b64_tr_b16 v[34:35], v92 offset:47616
    ds_read_b128 v[36:39], v91 offset:40960
    s_waitcnt lgkmcnt(9)
    v_mfma_f32_32x32x16_bf16 v[64:79], v[8:11], v[12:15], v[64:79]
    v_readfirstlane_b32 s8, v6
    s_nop 0
    s_cmp_ge_u32 s8, 4
    s_cbranch_scc0 L_k3
L_k3_ok:
    ds_read_b64_tr_b16 v[8:9], v92 offset:49152
    ds_read_b64_tr_b16 v[10:11], v92 offset:49664
    ds_read_b128 v[12:15], v88 offset:49152
    s_waitcnt lgkmcnt(9)
    v_mfma_f32_32x32x16_bf16 v[64:79], v[16:19], v[20:23], v[64:79]
    ds_read_b64_tr_b16 v[16:17], v92 offset:51200
    ds_read_b64_tr_b16 v[18:19], v92 offset:51712
    ds_read_b128 v[20:23], v89 offset:49152
    s_waitcnt lgkmcnt(9)
    v_mfma_f32_32x32x16_bf16 v[64:79], v[24:27], v[28:31], v[64:79]
    ds_read_b64_tr_b16 v[24:25], v92 offset:53248
    ds_read_b64_tr_b16 v[26:27], v92 offset:53760
    ds_read_b128 v[28:31], v90 offset:49152
    s_waitcnt lgkmcnt(9)
    v_mfma_f32_32x32x16_bf16 v[64:79], v[32:35], v[36:39], v[64:79]
    ds_read_b64_tr_b16 v[32:33], v92 offset:55296
    ds_read_b64_tr_b16 v[34:35], v92 offset:55808
    ds_read_b128 v[36:39], v91 offset:49152
    s_waitcnt lgkmcnt(9)
    v_mfma_f32_32x32x16_bf16 v[64:79], v[8:11], v[12:15], v[64:79]
    ds_read_b64_tr_b16 v[8:9], v92 offset:57344
    ds_read_b64_tr_b16 v[10:11], v92 offset:57856
    ds_read_b128 v[12:15], v88 offset:57344
    s_waitcnt lgkmcnt(9)
    v_mfma_f32_32x32x16_bf16 v[64:79], v[16:19], v[20:23], v[64:79]
    ds_read_b64_tr_b16 v[16:17], v92 offset:59392
    ds_read_b64_tr_b16 v[18:19], v92 offset:59904
    ds_read_b128 v[20:23], v89 offset:57344
    s_waitcnt lgkmcnt(9)
    v_mfma_f32_32x32x16_bf16 v[64:79], v[24:27], v[28:31], v[64:79]
    ds_read_b64_tr_b16 v[24:25], v92 offset:61440
    ds_read_b64_tr_b16 v[26:27], v92 offset:61952
    ds_read_b128 v[28:31], v90 offset:57344
    s_waitcnt lgkmcnt(9)
    v_mfma_f32_32x32x16_bf16 v[64:79], v[32:35], v[36:39], v[64:79]
    ds_read_b64_tr_b16 v[32:33], v92 offset:63488
    ds_read_b64_tr_b16 v[34:35], v92 offset:64000
    ds_read_b128 v[36:39], v91 offset:57344
    s_waitcnt lgkmcnt(9)
    v_mfma_f32_32x32x16_bf16 v[64:79], v[8:11], v[12:15], v[64:79]
    s_waitcnt lgkmcnt(6)
    v_mfma_f32_32x32x16_bf16 v[64:79], v[16:19], v[20:23], v[64:79]
    s_waitcnt lgkmcnt(3)
    v_mfma_f32_32x32x16_bf16 v[64:79], v[24:27], v[28:31], v[64:79]
    s_waitcnt lgkmcnt(0)
    v_mfma_f32_32x32x16_bf16 v[64:79], v[32:35], v[36:39], v[64:79]
    s_nop 11
    v_cvt_pk_bf16_f32 v80, v64, v65
    v_cvt_pk_bf16_f32 v81, v66, v67
    v_cvt_pk_bf16_f32 v82, v68, v69
    v_cvt_pk_bf16_f32 v83, v70, v71
    v_cvt_pk_bf16_f32 v84, v72, v73
    v_cvt_pk_bf16_f32 v85, v74, v75
    v_cvt_pk_bf16_f32 v86, v76, v77
    v_cvt_pk_bf16_f32 v87, v78, v79
    ds_write_b128 v95, v[80:83] offset:0
    ds_write_b128 v95, v[84:87] offset:2048
    s_mov_b64 exec, 1
    ds_add_u32 v93, v7 offset:16
    s_mov_b64 exec, -1
    s_waitcnt vmcnt(0)
    v_cmp_ne_u32 vcc, s59, v5
    s_cbranch_vccnz L_tagr
L_tag_ok:
    buffer_load_dwordx4 v[40:43], v2, s[76:79], s66 offen offset:0 sc1
    buffer_load_dwordx4 v[44:47], v3, s[76:79], s66 offen offset:1024 sc1
    buffer_load_dwordx4 v[48:51], v1, s[76:79], s66 offen offset:1024 sc1
    buffer_load_dword v117, v116, s[68:71], s66 offen sc1
    buffer_load_dwordx4 v[52:55], v2, s[76:79], s66 offen offset:2304 sc1
    buffer_load_dwordx4 v[56:59], v3, s[76:79], s66 offen offset:3328 sc1
    buffer_load_dwordx4 v[60:63], v1, s[76:79], s66 offen offset:3328 sc1
    buffer_load_dwordx4 v[104:107], v2, s[76:79], s62 offen offset:0 sc1
    buffer_load_dwordx4 v[108:111], v3, s[76:79], s62 offen offset:1024 sc1
    buffer_load_dwordx4 v[112:115], v1, s[76:79], s62 offen offset:1024 sc1
L_qwait:
    ds_read_b32 v92, v93 offset:16
    ds_read_b128 v[8:11], v96 offset:0
    ds_read_b128 v[12:15], v96 offset:1024
    ds_read_b128 v[16:19], v97 offset:0
    ds_read_b128 v[20:23], v97 offset:1024
    ds_read_b128 v[24:27], v98 offset:0
    ds_read_b128 v[28:31], v98 offset:1024
    ds_read_b128 v[32:35], v99 offset:0
    ds_read_b128 v[36:39], v99 offset:1024
    s_waitcnt lgkmcnt(0)
    v_readfirstlane_b32 s8, v92
    s_nop 0
    s_cmp_ge_u32 s8, 4
    s_cbranch_scc0 L_qwait
    v_mov_b32 v4, v93
    v_mov_b32 v5, 1
    s_waitcnt vmcnt(0)
    v_max3_u32 v6, v40, v44, v48
    v_max3_u32 v7, v52, v56, v60
    v_max3_u32 v6, v6, v104, v108
    v_max3_u32 v6, v6, v7, v112
    v_max_u32 v6, v6, v117
    v_cmp_eq_u32 vcc, -1, v6
    s_cbranch_vccnz L_kvr_first
L_kv_first_ok:
    s_mov_b64 exec, 1
    ds_add_u32 v4, v5 offset:28
    s_mov_b64 exec, -1
    v_mfma_f32_32x32x16_bf16 v[64:79], v[40:43], v[8:11], 0
    s_setprio 1
    v_add_u32 v6, s67, v2
    v_lshlrev_b32 v7, 2, v0
    s_add_u32 s67, s67, 4096
    v_add_u32 v7, s67, v7
    s_mov_b32 s64, 4
    s_nop 4
    s_branch L_attn_in
.p2align 6
L_attn_loop:
    v_exp_f32 v64, v64
    v_exp_f32 v65, v65
    v_exp_f32 v66, v66
    v_mfma_f32_32x32x16_bf16 v[240:255], v[112:115], v[100:103], v[240:255]
    s_add_u32 s62, s62, 2304
    v_exp_f32 v67, v67
    v_exp_f32 v68, v68
    v_exp_f32 v69, v69
    v_mfma_f32_32x32x16_bf16 v[80:95], v[116:119], v[12:15], 0
    v_exp_f32 v70, v70
    v_exp_f32 v71, v71
    v_cvt_pk_bf16_f32 v96, v64, v65
    v_cvt_pk_bf16_f32 v97, v66, v67
    v_cvt_pk_bf16_f32 v98, v68, v69
    v_cvt_pk_bf16_f32 v99, v70, v71
    v_exp_f32 v72, v72
    v_exp_f32 v73, v73
    v_mfma_f32_32x32x16_bf16 v[128:143], v[120:123], v[96:99], v[128:143]
    buffer_load_dwordx4 v[104:107], v2, s[76:79], s62 offen offset:0 sc1
    buffer_load_dwordx4 v[108:111], v3, s[76:79], s62 offen offset:1024 sc1
    buffer_load_dwordx4 v[112:115], v1, s[76:79], s62 offen offset:1024 sc1
    v_exp_f32 v74, v74
    v_exp_f32 v75, v75
    v_exp_f32 v76, v76
    v_exp_f32 v77, v77
    v_exp_f32 v78, v78
    v_exp_f32 v79, v79
    v_cvt_pk_bf16_f32 v100, v72, v73
    v_cvt_pk_bf16_f32 v101, v74, v75
    v_cvt_pk_bf16_f32 v102, v76, v77
    v_cvt_pk_bf16_f32 v103, v78, v79
    v_exp_f32 v80, v80
    v_exp_f32 v81, v81
    v_exp_f32 v82, v82
    v_mfma_f32_32x32x16_bf16 v[128:143], v[124:127], v[100:103], v[128:143]
    v_exp_f32 v83, v83
    v_exp_f32 v84, v84
    v_exp_f32 v85, v85
    v_mfma_f32_32x32x16_bf16 v[64:79], v[116:119], v[16:19], 0
    v_exp_f32 v86, v86
    v_exp_f32 v87, v87
    v_cvt_pk_bf16_f32 v96, v80, v81
    v_cvt_pk_bf16_f32 v97, v82, v83
    v_cvt_pk_bf16_f32 v98, v84, v85
    v_cvt_pk_bf16_f32 v99, v86, v87
    v_exp_f32 v88, v88
    v_exp_f32 v89, v89
    v_mfma_f32_32x32x16_bf16 v[144:159], v[120:123], v[96:99], v[144:159]
    v_exp_f32 v90, v90
    v_exp_f32 v91, v91
    v_exp_f32 v92, v92
    v_exp_f32 v93, v93
    v_exp_f32 v94, v94
    v_exp_f32 v95, v95
    v_cvt_pk_bf16_f32 v100, v88, v89
    v_cvt_pk_bf16_f32 v101, v90, v91
    v_cvt_pk_bf16_f32 v102, v92, v93
    v_cvt_pk_bf16_f32 v103, v94, v95
    v_exp_f32 v64, v64
    v_exp_f32 v65, v65
    v_exp_f32 v66, v66
    v_mfma_f32_32x32x16_bf16 v[144:159], v[124:127], v[100:103], v[144:159]
    v_exp_f32 v67, v67
    v_exp_f32 v68, v68
    v_exp_f32 v69, v69
    v_mfma_f32_32x32x16_bf16 v[80:95], v[116:119], v[20:23], 0
    v_exp_f32 v70, v70
    v_exp_f32 v71, v71
    v_cvt_pk_bf16_f32 v96, v64, v65
    v_cvt_pk_bf16_f32 v97, v66, v67
    v_cvt_pk_bf16_f32 v98, v68, v69
    v_cvt_pk_bf16_f32 v99, v70, v71
    v_exp_f32 v72, v72
    v_exp_f32 v73, v73
    v_mfma_f32_32x32x16_bf16 v[160:175], v[120:123], v[96:99], v[160:175]
    v_exp_f32 v74, v74
    v_exp_f32 v75, v75
    v_exp_f32 v76, v76
    v_exp_f32 v77, v77
    v_exp_f32 v78, v78
    v_exp_f32 v79, v79
    v_cvt_pk_bf16_f32 v100, v72, v73
    v_cvt_pk_bf16_f32 v101, v74, v75
    v_cvt_pk_bf16_f32 v102, v76, v77
    v_cvt_pk_bf16_f32 v103, v78, v79
    v_exp_f32 v80, v80
    v_exp_f32 v81, v81
    v_exp_f32 v82, v82
    v_mfma_f32_32x32x16_bf16 v[160:175], v[124:127], v[100:103], v[160:175]
    v_exp_f32 v83, v83
    v_exp_f32 v84, v84
    v_exp_f32 v85, v85
    v_mfma_f32_32x32x16_bf16 v[64:79], v[116:119], v[24:27], 0
    v_exp_f32 v86, v86
    v_exp_f32 v87, v87
    v_cvt_pk_bf16_f32 v96, v80, v81
    v_cvt_pk_bf16_f32 v97, v82, v83
    v_cvt_pk_bf16_f32 v98, v84, v85
    v_cvt_pk_bf16_f32 v99, v86, v87
    v_exp_f32 v88, v88
    v_exp_f32 v89, v89
    v_mfma_f32_32x32x16_bf16 v[176:191], v[120:123], v[96:99], v[176:191]
    v_exp_f32 v90, v90
    v_exp_f32 v91, v91
    v_exp_f32 v92, v92
    v_exp_f32 v93, v93
    v_exp_f32 v94, v94
    v_exp_f32 v95, v95
    v_cvt_pk_bf16_f32 v100, v88, v89
    v_cvt_pk_bf16_f32 v101, v90, v91
    v_cvt_pk_bf16_f32 v102, v92, v93
    v_cvt_pk_bf16_f32 v103, v94, v95
    v_exp_f32 v64, v64
    v_exp_f32 v65, v65
    v_exp_f32 v66, v66
    v_mfma_f32_32x32x16_bf16 v[176:191], v[124:127], v[100:103], v[176:191]
    v_exp_f32 v67, v67
    v_exp_f32 v68, v68
    v_exp_f32 v69, v69
    v_mfma_f32_32x32x16_bf16 v[80:95], v[116:119], v[28:31], 0
    v_exp_f32 v70, v70
    v_exp_f32 v71, v71
    v_cvt_pk_bf16_f32 v96, v64, v65
    v_cvt_pk_bf16_f32 v97, v66, v67
    v_cvt_pk_bf16_f32 v98, v68, v69
    v_cvt_pk_bf16_f32 v99, v70, v71
    v_exp_f32 v72, v72
    v_exp_f32 v73, v73
    v_mfma_f32_32x32x16_bf16 v[192:207], v[120:123], v[96:99], v[192:207]
    v_exp_f32 v74, v74
    v_exp_f32 v75, v75
    v_exp_f32 v76, v76
    v_exp_f32 v77, v77
    v_exp_f32 v78, v78
    v_exp_f32 v79, v79
    v_cvt_pk_bf16_f32 v100, v72, v73
    v_cvt_pk_bf16_f32 v101, v74, v75
    v_cvt_pk_bf16_f32 v102, v76, v77
    v_cvt_pk_bf16_f32 v103, v78, v79
    v_exp_f32 v80, v80
    v_exp_f32 v81, v81
    v_exp_f32 v82, v82
    v_mfma_f32_32x32x16_bf16 v[192:207], v[124:127], v[100:103], v[192:207]
    v_exp_f32 v83, v83
    v_exp_f32 v84, v84
    v_exp_f32 v85, v85
    v_mfma_f32_32x32x16_bf16 v[64:79], v[116:119], v[32:35], 0
    v_exp_f32 v86, v86
    v_exp_f32 v87, v87
    v_cvt_pk_bf16_f32 v96, v80, v81
    v_cvt_pk_bf16_f32 v97, v82, v83
    v_cvt_pk_bf16_f32 v98, v84, v85
    v_cvt_pk_bf16_f32 v99, v86, v87
    v_exp_f32 v88, v88
    v_exp_f32 v89, v89
    v_mfma_f32_32x32x16_bf16 v[208:223], v[120:123], v[96:99], v[208:223]
    v_exp_f32 v90, v90
    v_exp_f32 v91, v91
    v_exp_f32 v92, v92
    v_exp_f32 v93, v93
    v_exp_f32 v94, v94
    v_exp_f32 v95, v95
    v_cvt_pk_bf16_f32 v100, v88, v89
    v_cvt_pk_bf16_f32 v101, v90, v91
    v_cvt_pk_bf16_f32 v102, v92, v93
    v_cvt_pk_bf16_f32 v103, v94, v95
    v_exp_f32 v64, v64
    v_exp_f32 v65, v65
    v_exp_f32 v66, v66
    v_mfma_f32_32x32x16_bf16 v[208:223], v[124:127], v[100:103], v[208:223]
    v_exp_f32 v67, v67
    v_exp_f32 v68, v68
    v_exp_f32 v69, v69
    v_mfma_f32_32x32x16_bf16 v[80:95], v[116:119], v[36:39], 0
    v_exp_f32 v70, v70
    v_exp_f32 v71, v71
    v_cvt_pk_bf16_f32 v96, v64, v65
    v_cvt_pk_bf16_f32 v97, v66, v67
    v_cvt_pk_bf16_f32 v98, v68, v69
    v_cvt_pk_bf16_f32 v99, v70, v71
    v_exp_f32 v72, v72
    v_exp_f32 v73, v73
    v_mfma_f32_32x32x16_bf16 v[224:239], v[120:123], v[96:99], v[224:239]
    v_exp_f32 v74, v74
    v_exp_f32 v75, v75
    v_exp_f32 v76, v76
    v_exp_f32 v77, v77
    v_exp_f32 v78, v78
    v_exp_f32 v79, v79
    v_cvt_pk_bf16_f32 v100, v72, v73
    v_cvt_pk_bf16_f32 v101, v74, v75
    v_cvt_pk_bf16_f32 v102, v76, v77
    v_cvt_pk_bf16_f32 v103, v78, v79
    v_exp_f32 v80, v80
    v_exp_f32 v81, v81
    v_exp_f32 v82, v82
    v_mfma_f32_32x32x16_bf16 v[224:239], v[124:127], v[100:103], v[224:239]
    s_waitcnt vmcnt(6)
    v_exp_f32 v83, v83
    v_exp_f32 v84, v84
    v_exp_f32 v85, v85
    v_mfma_f32_32x32x16_bf16 v[64:79], v[40:43], v[8:11], 0
    v_exp_f32 v86, v86
    v_exp_f32 v87, v87
    v_cvt_pk_bf16_f32 v96, v80, v81
    v_cvt_pk_bf16_f32 v97, v82, v83
    v_cvt_pk_bf16_f32 v98, v84, v85
    v_cvt_pk_bf16_f32 v99, v86, v87
    v_exp_f32 v88, v88
    v_exp_f32 v89, v89
    v_mfma_f32_32x32x16_bf16 v[240:255], v[120:123], v[96:99], v[240:255]
    v_exp_f32 v90, v90
    v_exp_f32 v91, v91
    v_exp_f32 v92, v92
    v_exp_f32 v93, v93
    v_exp_f32 v94, v94
    v_exp_f32 v95, v95
    v_cvt_pk_bf16_f32 v100, v88, v89
    v_cvt_pk_bf16_f32 v101, v90, v91
    v_cvt_pk_bf16_f32 v102, v92, v93
    v_cvt_pk_bf16_f32 v103, v94, v95
L_attn_in:
    v_exp_f32 v64, v64
    v_exp_f32 v65, v65
    v_exp_f32 v66, v66
    v_mfma_f32_32x32x16_bf16 v[240:255], v[124:127], v[100:103], v[240:255]
    s_add_u32 s62, s62, 2304
    v_exp_f32 v67, v67
    v_exp_f32 v68, v68
    v_exp_f32 v69, v69
    v_mfma_f32_32x32x16_bf16 v[80:95], v[40:43], v[12:15], 0
    v_exp_f32 v70, v70
    v_exp_f32 v71, v71
    v_cvt_pk_bf16_f32 v96, v64, v65
    v_cvt_pk_bf16_f32 v97, v66, v67
    v_cvt_pk_bf16_f32 v98, v68, v69
    v_cvt_pk_bf16_f32 v99, v70, v71
    v_exp_f32 v72, v72
    v_exp_f32 v73, v73
    v_mfma_f32_32x32x16_bf16 v[128:143], v[44:47], v[96:99], v[128:143]
    buffer_load_dwordx4 v[116:119], v2, s[76:79], s62 offen offset:0 sc1
    buffer_load_dwordx4 v[120:123], v3, s[76:79], s62 offen offset:1024 sc1
    buffer_load_dwordx4 v[124:127], v1, s[76:79], s62 offen offset:1024 sc1
    v_exp_f32 v74, v74
    v_exp_f32 v75, v75
    v_exp_f32 v76, v76
    v_exp_f32 v77, v77
    v_exp_f32 v78, v78
    v_exp_f32 v79, v79
    v_cvt_pk_bf16_f32 v100, v72, v73
    v_cvt_pk_bf16_f32 v101, v74, v75
    v_cvt_pk_bf16_f32 v102, v76, v77
    v_cvt_pk_bf16_f32 v103, v78, v79
    v_exp_f32 v80, v80
    v_exp_f32 v81, v81
    v_exp_f32 v82, v82
    v_mfma_f32_32x32x16_bf16 v[128:143], v[48:51], v[100:103], v[128:143]
    v_exp_f32 v83, v83
    v_exp_f32 v84, v84
    v_exp_f32 v85, v85
    v_mfma_f32_32x32x16_bf16 v[64:79], v[40:43], v[16:19], 0
    v_exp_f32 v86, v86
    v_exp_f32 v87, v87
    v_cvt_pk_bf16_f32 v96, v80, v81
    v_cvt_pk_bf16_f32 v97, v82, v83
    v_cvt_pk_bf16_f32 v98, v84, v85
    v_cvt_pk_bf16_f32 v99, v86, v87
    v_exp_f32 v88, v88
    v_exp_f32 v89, v89
    v_mfma_f32_32x32x16_bf16 v[144:159], v[44:47], v[96:99], v[144:159]
    v_exp_f32 v90, v90
    v_exp_f32 v91, v91
    v_exp_f32 v92, v92
    v_exp_f32 v93, v93
    v_exp_f32 v94, v94
    v_exp_f32 v95, v95
    v_cvt_pk_bf16_f32 v100, v88, v89
    v_cvt_pk_bf16_f32 v101, v90, v91
    v_cvt_pk_bf16_f32 v102, v92, v93
    v_cvt_pk_bf16_f32 v103, v94, v95
    v_exp_f32 v64, v64
    v_exp_f32 v65, v65
    v_exp_f32 v66, v66
    v_mfma_f32_32x32x16_bf16 v[144:159], v[48:51], v[100:103], v[144:159]
    v_exp_f32 v67, v67
    v_exp_f32 v68, v68
    v_exp_f32 v69, v69
    v_mfma_f32_32x32x16_bf16 v[80:95], v[40:43], v[20:23], 0
    v_exp_f32 v70, v70
    v_exp_f32 v71, v71
    v_cvt_pk_bf16_f32 v96, v64, v65
    v_cvt_pk_bf16_f32 v97, v66, v67
    v_cvt_pk_bf16_f32 v98, v68, v69
    v_cvt_pk_bf16_f32 v99, v70, v71
    v_exp_f32 v72, v72
    v_exp_f32 v73, v73
    v_mfma_f32_32x32x16_bf16 v[160:175], v[44:47], v[96:99], v[160:175]
    v_exp_f32 v74, v74
    v_exp_f32 v75, v75
    v_exp_f32 v76, v76
    v_exp_f32 v77, v77
    v_exp_f32 v78, v78
    v_exp_f32 v79, v79
    v_cvt_pk_bf16_f32 v100, v72, v73
    v_cvt_pk_bf16_f32 v101, v74, v75
    v_cvt_pk_bf16_f32 v102, v76, v77
    v_cvt_pk_bf16_f32 v103, v78, v79
    v_exp_f32 v80, v80
    v_exp_f32 v81, v81
    v_exp_f32 v82, v82
    v_mfma_f32_32x32x16_bf16 v[160:175], v[48:51], v[100:103], v[160:175]
    v_exp_f32 v83, v83
    v_exp_f32 v84, v84
    v_exp_f32 v85, v85
    v_mfma_f32_32x32x16_bf16 v[64:79], v[40:43], v[24:27], 0
    v_exp_f32 v86, v86
    v_exp_f32 v87, v87
    v_cvt_pk_bf16_f32 v96, v80, v81
    v_cvt_pk_bf16_f32 v97, v82, v83
    v_cvt_pk_bf16_f32 v98, v84, v85
    v_cvt_pk_bf16_f32 v99, v86, v87
    v_exp_f32 v88, v88
    v_exp_f32 v89, v89
    v_mfma_f32_32x32x16_bf16 v[176:191], v[44:47], v[96:99], v[176:191]
    v_exp_f32 v90, v90
    v_exp_f32 v91, v91
    v_exp_f32 v92, v92
    v_exp_f32 v93, v93
    v_exp_f32 v94, v94
    v_exp_f32 v95, v95
    v_cvt_pk_bf16_f32 v100, v88, v89
    v_cvt_pk_bf16_f32 v101, v90, v91
    v_cvt_pk_bf16_f32 v102, v92, v93
    v_cvt_pk_bf16_f32 v103, v94, v95
    v_exp_f32 v64, v64
    v_exp_f32 v65, v65
    v_exp_f32 v66, v66
    v_mfma_f32_32x32x16_bf16 v[176:191], v[48:51], v[100:103], v[176:191]
    v_exp_f32 v67, v67
    v_exp_f32 v68, v68
    v_exp_f32 v69, v69
    v_mfma_f32_32x32x16_bf16 v[80:95], v[40:43], v[28:31], 0
    v_exp_f32 v70, v70
    v_exp_f32 v71, v71
    v_cvt_pk_bf16_f32 v96, v64, v65
    v_cvt_pk_bf16_f32 v97, v66, v67
    v_cvt_pk_bf16_f32 v98, v68, v69
    v_cvt_pk_bf16_f32 v99, v70, v71
    v_exp_f32 v72, v72
    v_exp_f32 v73, v73
    v_mfma_f32_32x32x16_bf16 v[192:207], v[44:47], v[96:99], v[192:207]
    v_exp_f32 v74, v74
    v_exp_f32 v75, v75
    v_exp_f32 v76, v76
    v_exp_f32 v77, v77
    v_exp_f32 v78, v78
    v_exp_f32 v79, v79
    v_cvt_pk_bf16_f32 v100, v72, v73
    v_cvt_pk_bf16_f32 v101, v74, v75
    v_cvt_pk_bf16_f32 v102, v76, v77
    v_cvt_pk_bf16_f32 v103, v78, v79
    v_exp_f32 v80, v80
    v_exp_f32 v81, v81
    v_exp_f32 v82, v82
    v_mfma_f32_32x32x16_bf16 v[192:207], v[48:51], v[100:103], v[192:207]
    v_exp_f32 v83, v83
    v_exp_f32 v84, v84
    v_exp_f32 v85, v85
    v_mfma_f32_32x32x16_bf16 v[64:79], v[40:43], v[32:35], 0
    v_exp_f32 v86, v86
    v_exp_f32 v87, v87
    v_cvt_pk_bf16_f32 v96, v80, v81
    v_cvt_pk_bf16_f32 v97, v82, v83
    v_cvt_pk_bf16_f32 v98, v84, v85
    v_cvt_pk_bf16_f32 v99, v86, v87
    v_exp_f32 v88, v88
    v_exp_f32 v89, v89
    v_mfma_f32_32x32x16_bf16 v[208:223], v[44:47], v[96:99], v[208:223]
    v_exp_f32 v90, v90
    v_exp_f32 v91, v91
    v_exp_f32 v92, v92
    v_exp_f32 v93, v93
    v_exp_f32 v94, v94
    v_exp_f32 v95, v95
    v_cvt_pk_bf16_f32 v100, v88, v89
    v_cvt_pk_bf16_f32 v101, v90, v91
    v_cvt_pk_bf16_f32 v102, v92, v93
    v_cvt_pk_bf16_f32 v103, v94, v95
    v_exp_f32 v64, v64
    v_exp_f32 v65, v65
    v_exp_f32 v66, v66
    v_mfma_f32_32x32x16_bf16 v[208:223], v[48:51], v[100:103], v[208:223]
    v_exp_f32 v67, v67
    v_exp_f32 v68, v68
    v_exp_f32 v69, v69
    v_mfma_f32_32x32x16_bf16 v[80:95], v[40:43], v[36:39], 0
    v_exp_f32 v70, v70
    v_exp_f32 v71, v71
    v_cvt_pk_bf16_f32 v96, v64, v65
    v_cvt_pk_bf16_f32 v97, v66, v67
    v_cvt_pk_bf16_f32 v98, v68, v69
    v_cvt_pk_bf16_f32 v99, v70, v71
    v_exp_f32 v72, v72
    v_exp_f32 v73, v73
    v_mfma_f32_32x32x16_bf16 v[224:239], v[44:47], v[96:99], v[224:239]
    v_exp_f32 v74, v74
    v_exp_f32 v75, v75
    v_exp_f32 v76, v76
    v_exp_f32 v77, v77
    v_exp_f32 v78, v78
    v_exp_f32 v79, v79
    v_cvt_pk_bf16_f32 v100, v72, v73
    v_cvt_pk_bf16_f32 v101, v74, v75
    v_cvt_pk_bf16_f32 v102, v76, v77
    v_cvt_pk_bf16_f32 v103, v78, v79
    v_exp_f32 v80, v80
    v_exp_f32 v81, v81
    v_exp_f32 v82, v82
    v_mfma_f32_32x32x16_bf16 v[224:239], v[48:51], v[100:103], v[224:239]
    s_waitcnt vmcnt(6)
    v_exp_f32 v83, v83
    v_exp_f32 v84, v84
    v_exp_f32 v85, v85
    v_mfma_f32_32x32x16_bf16 v[64:79], v[52:55], v[8:11], 0
    v_exp_f32 v86, v86
    v_exp_f32 v87, v87
    v_cvt_pk_bf16_f32 v96, v80, v81
    v_cvt_pk_bf16_f32 v97, v82, v83
    v_cvt_pk_bf16_f32 v98, v84, v85
    v_cvt_pk_bf16_f32 v99, v86, v87
    v_exp_f32 v88, v88
    v_exp_f32 v89, v89
    v_mfma_f32_32x32x16_bf16 v[240:255], v[44:47], v[96:99], v[240:255]
    v_exp_f32 v90, v90
    v_exp_f32 v91, v91
    v_exp_f32 v92, v92
    v_exp_f32 v93, v93
    v_exp_f32 v94, v94
    v_exp_f32 v95, v95
    v_cvt_pk_bf16_f32 v100, v88, v89
    v_cvt_pk_bf16_f32 v101, v90, v91
    v_cvt_pk_bf16_f32 v102, v92, v93
    v_cvt_pk_bf16_f32 v103, v94, v95
    v_exp_f32 v64, v64
    v_exp_f32 v65, v65
    v_exp_f32 v66, v66
    v_mfma_f32_32x32x16_bf16 v[240:255], v[48:51], v[100:103], v[240:255]
    s_add_u32 s62, s62, 2304
    v_exp_f32 v67, v67
    v_exp_f32 v68, v68
    v_exp_f32 v69, v69
    v_mfma_f32_32x32x16_bf16 v[80:95], v[52:55], v[12:15], 0
    v_exp_f32 v70, v70
    v_exp_f32 v71, v71
    v_cvt_pk_bf16_f32 v96, v64, v65
    v_cvt_pk_bf16_f32 v97, v66, v67
    v_cvt_pk_bf16_f32 v98, v68, v69
    v_cvt_pk_bf16_f32 v99, v70, v71
    v_exp_f32 v72, v72
    v_exp_f32 v73, v73
    v_mfma_f32_32x32x16_bf16 v[128:143], v[56:59], v[96:99], v[128:143]
    buffer_load_dwordx4 v[40:43], v2, s[76:79], s62 offen offset:0 sc1
    buffer_load_dwordx4 v[44:47], v3, s[76:79], s62 offen offset:1024 sc1
    buffer_load_dwordx4 v[48:51], v1, s[76:79], s62 offen offset:1024 sc1
    v_exp_f32 v74, v74
    v_exp_f32 v75, v75
    v_exp_f32 v76, v76
    v_exp_f32 v77, v77
    v_exp_f32 v78, v78
    v_exp_f32 v79, v79
    v_cvt_pk_bf16_f32 v100, v72, v73
    v_cvt_pk_bf16_f32 v101, v74, v75
    v_cvt_pk_bf16_f32 v102, v76, v77
    v_cvt_pk_bf16_f32 v103, v78, v79
    v_exp_f32 v80, v80
    v_exp_f32 v81, v81
    v_exp_f32 v82, v82
    v_mfma_f32_32x32x16_bf16 v[128:143], v[60:63], v[100:103], v[128:143]
    v_exp_f32 v83, v83
    v_exp_f32 v84, v84
    v_exp_f32 v85, v85
    v_mfma_f32_32x32x16_bf16 v[64:79], v[52:55], v[16:19], 0
    v_exp_f32 v86, v86
    v_exp_f32 v87, v87
    v_cvt_pk_bf16_f32 v96, v80, v81
    v_cvt_pk_bf16_f32 v97, v82, v83
    v_cvt_pk_bf16_f32 v98, v84, v85
    v_cvt_pk_bf16_f32 v99, v86, v87
    v_exp_f32 v88, v88
    v_exp_f32 v89, v89
    v_mfma_f32_32x32x16_bf16 v[144:159], v[56:59], v[96:99], v[144:159]
    v_exp_f32 v90, v90
    v_exp_f32 v91, v91
    v_exp_f32 v92, v92
    v_exp_f32 v93, v93
    v_exp_f32 v94, v94
    v_exp_f32 v95, v95
    v_cvt_pk_bf16_f32 v100, v88, v89
    v_cvt_pk_bf16_f32 v101, v90, v91
    v_cvt_pk_bf16_f32 v102, v92, v93
    v_cvt_pk_bf16_f32 v103, v94, v95
    v_exp_f32 v64, v64
    v_exp_f32 v65, v65
    v_exp_f32 v66, v66
    v_mfma_f32_32x32x16_bf16 v[144:159], v[60:63], v[100:103], v[144:159]
    v_exp_f32 v67, v67
    v_exp_f32 v68, v68
    v_exp_f32 v69, v69
    v_mfma_f32_32x32x16_bf16 v[80:95], v[52:55], v[20:23], 0
    v_exp_f32 v70, v70
    v_exp_f32 v71, v71
    v_cvt_pk_bf16_f32 v96, v64, v65
    v_cvt_pk_bf16_f32 v97, v66, v67
    v_cvt_pk_bf16_f32 v98, v68, v69
    v_cvt_pk_bf16_f32 v99, v70, v71
    v_exp_f32 v72, v72
    v_exp_f32 v73, v73
    v_mfma_f32_32x32x16_bf16 v[160:175], v[56:59], v[96:99], v[160:175]
    v_exp_f32 v74, v74
    v_exp_f32 v75, v75
    v_exp_f32 v76, v76
    v_exp_f32 v77, v77
    v_exp_f32 v78, v78
    v_exp_f32 v79, v79
    v_cvt_pk_bf16_f32 v100, v72, v73
    v_cvt_pk_bf16_f32 v101, v74, v75
    v_cvt_pk_bf16_f32 v102, v76, v77
    v_cvt_pk_bf16_f32 v103, v78, v79
    v_exp_f32 v80, v80
    v_exp_f32 v81, v81
    v_exp_f32 v82, v82
    v_mfma_f32_32x32x16_bf16 v[160:175], v[60:63], v[100:103], v[160:175]
    v_exp_f32 v83, v83
    v_exp_f32 v84, v84
    v_exp_f32 v85, v85
    v_mfma_f32_32x32x16_bf16 v[64:79], v[52:55], v[24:27], 0
    v_exp_f32 v86, v86
    v_exp_f32 v87, v87
    v_cvt_pk_bf16_f32 v96, v80, v81
    v_cvt_pk_bf16_f32 v97, v82, v83
    v_cvt_pk_bf16_f32 v98, v84, v85
    v_cvt_pk_bf16_f32 v99, v86, v87
    v_exp_f32 v88, v88
    v_exp_f32 v89, v89
    v_mfma_f32_32x32x16_bf16 v[176:191], v[56:59], v[96:99], v[176:191]
    v_exp_f32 v90, v90
    v_exp_f32 v91, v91
    v_exp_f32 v92, v92
    v_exp_f32 v93, v93
    v_exp_f32 v94, v94
    v_exp_f32 v95, v95
    v_cvt_pk_bf16_f32 v100, v88, v89
    v_cvt_pk_bf16_f32 v101, v90, v91
    v_cvt_pk_bf16_f32 v102, v92, v93
    v_cvt_pk_bf16_f32 v103, v94, v95
    v_exp_f32 v64, v64
    v_exp_f32 v65, v65
    v_exp_f32 v66, v66
    v_mfma_f32_32x32x16_bf16 v[176:191], v[60:63], v[100:103], v[176:191]
    v_exp_f32 v67, v67
    v_exp_f32 v68, v68
    v_exp_f32 v69, v69
    v_mfma_f32_32x32x16_bf16 v[80:95], v[52:55], v[28:31], 0
    v_exp_f32 v70, v70
    v_exp_f32 v71, v71
    v_cvt_pk_bf16_f32 v96, v64, v65
    v_cvt_pk_bf16_f32 v97, v66, v67
    v_cvt_pk_bf16_f32 v98, v68, v69
    v_cvt_pk_bf16_f32 v99, v70, v71
    v_exp_f32 v72, v72
    v_exp_f32 v73, v73
    v_mfma_f32_32x32x16_bf16 v[192:207], v[56:59], v[96:99], v[192:207]
    v_exp_f32 v74, v74
    v_exp_f32 v75, v75
    v_exp_f32 v76, v76
    v_exp_f32 v77, v77
    v_exp_f32 v78, v78
    v_exp_f32 v79, v79
    v_cvt_pk_bf16_f32 v100, v72, v73
    v_cvt_pk_bf16_f32 v101, v74, v75
    v_cvt_pk_bf16_f32 v102, v76, v77
    v_cvt_pk_bf16_f32 v103, v78, v79
    v_exp_f32 v80, v80
    v_exp_f32 v81, v81
    v_exp_f32 v82, v82
    v_mfma_f32_32x32x16_bf16 v[192:207], v[60:63], v[100:103], v[192:207]
    v_exp_f32 v83, v83
    v_exp_f32 v84, v84
    v_exp_f32 v85, v85
    v_mfma_f32_32x32x16_bf16 v[64:79], v[52:55], v[32:35], 0
    v_exp_f32 v86, v86
    v_exp_f32 v87, v87
    v_cvt_pk_bf16_f32 v96, v80, v81
    v_cvt_pk_bf16_f32 v97, v82, v83
    v_cvt_pk_bf16_f32 v98, v84, v85
    v_cvt_pk_bf16_f32 v99, v86, v87
    v_exp_f32 v88, v88
    v_exp_f32 v89, v89
    v_mfma_f32_32x32x16_bf16 v[208:223], v[56:59], v[96:99], v[208:223]
    v_exp_f32 v90, v90
    v_exp_f32 v91, v91
    v_exp_f32 v92, v92
    v_exp_f32 v93, v93
    v_exp_f32 v94, v94
    v_exp_f32 v95, v95
    v_cvt_pk_bf16_f32 v100, v88, v89
    v_cvt_pk_bf16_f32 v101, v90, v91
    v_cvt_pk_bf16_f32 v102, v92, v93
    v_cvt_pk_bf16_f32 v103, v94, v95
    v_exp_f32 v64, v64
    v_exp_f32 v65, v65
    v_exp_f32 v66, v66
    v_mfma_f32_32x32x16_bf16 v[208:223], v[60:63], v[100:103], v[208:223]
    v_exp_f32 v67, v67
    v_exp_f32 v68, v68
    v_exp_f32 v69, v69
    v_mfma_f32_32x32x16_bf16 v[80:95], v[52:55], v[36:39], 0
    v_exp_f32 v70, v70
    v_exp_f32 v71, v71
    v_cvt_pk_bf16_f32 v96, v64, v65
    v_cvt_pk_bf16_f32 v97, v66, v67
    v_cvt_pk_bf16_f32 v98, v68, v69
    v_cvt_pk_bf16_f32 v99, v70, v71
    v_exp_f32 v72, v72
    v_exp_f32 v73, v73
    v_mfma_f32_32x32x16_bf16 v[224:239], v[56:59], v[96:99], v[224:239]
    v_exp_f32 v74, v74
    v_exp_f32 v75, v75
    v_exp_f32 v76, v76
    v_exp_f32 v77, v77
    v_exp_f32 v78, v78
    v_exp_f32 v79, v79
    v_cvt_pk_bf16_f32 v100, v72, v73
    v_cvt_pk_bf16_f32 v101, v74, v75
    v_cvt_pk_bf16_f32 v102, v76, v77
    v_cvt_pk_bf16_f32 v103, v78, v79
    v_exp_f32 v80, v80
    v_exp_f32 v81, v81
    v_exp_f32 v82, v82
    v_mfma_f32_32x32x16_bf16 v[224:239], v[60:63], v[100:103], v[224:239]
    s_waitcnt vmcnt(6)
    v_exp_f32 v83, v83
    v_exp_f32 v84, v84
    v_exp_f32 v85, v85
    v_mfma_f32_32x32x16_bf16 v[64:79], v[104:107], v[8:11], 0
    v_exp_f32 v86, v86
    v_exp_f32 v87, v87
    v_cvt_pk_bf16_f32 v96, v80, v81
    v_cvt_pk_bf16_f32 v97, v82, v83
    v_cvt_pk_bf16_f32 v98, v84, v85
    v_cvt_pk_bf16_f32 v99, v86, v87
    v_exp_f32 v88, v88
    v_exp_f32 v89, v89
    v_mfma_f32_32x32x16_bf16 v[240:255], v[56:59], v[96:99], v[240:255]
    v_exp_f32 v90, v90
    v_exp_f32 v91, v91
    v_exp_f32 v92, v92
    v_exp_f32 v93, v93
    v_exp_f32 v94, v94
    v_exp_f32 v95, v95
    v_cvt_pk_bf16_f32 v100, v88, v89
    v_cvt_pk_bf16_f32 v101, v90, v91
    v_cvt_pk_bf16_f32 v102, v92, v93
    v_cvt_pk_bf16_f32 v103, v94, v95
    v_exp_f32 v64, v64
    v_exp_f32 v65, v65
    v_exp_f32 v66, v66
    v_mfma_f32_32x32x16_bf16 v[240:255], v[60:63], v[100:103], v[240:255]
    s_add_u32 s62, s62, 2304
    v_exp_f32 v67, v67
    v_exp_f32 v68, v68
    v_exp_f32 v69, v69
    v_mfma_f32_32x32x16_bf16 v[80:95], v[104:107], v[12:15], 0
    v_exp_f32 v70, v70
    v_exp_f32 v71, v71
    v_cvt_pk_bf16_f32 v96, v64, v65
    v_cvt_pk_bf16_f32 v97, v66, v67
    v_cvt_pk_bf16_f32 v98, v68, v69
    v_cvt_pk_bf16_f32 v99, v70, v71
    v_exp_f32 v72, v72
    v_exp_f32 v73, v73
    v_mfma_f32_32x32x16_bf16 v[128:143], v[108:111], v[96:99], v[128:143]
    buffer_load_dwordx4 v[52:55], v2, s[76:79], s62 offen offset:0 sc1
    buffer_load_dwordx4 v[56:59], v3, s[76:79], s62 offen offset:1024 sc1
    buffer_load_dwordx4 v[60:63], v1, s[76:79], s62 offen offset:1024 sc1
    v_exp_f32 v74, v74
    v_exp_f32 v75, v75
    v_exp_f32 v76, v76
    v_exp_f32 v77, v77
    v_exp_f32 v78, v78
    v_exp_f32 v79, v79
    v_cvt_pk_bf16_f32 v100, v72, v73
    v_cvt_pk_bf16_f32 v101, v74, v75
    v_cvt_pk_bf16_f32 v102, v76, v77
    v_cvt_pk_bf16_f32 v103, v78, v79
    v_exp_f32 v80, v80
    v_exp_f32 v81, v81
    v_exp_f32 v82, v82
    v_mfma_f32_32x32x16_bf16 v[128:143], v[112:115], v[100:103], v[128:143]
    v_exp_f32 v83, v83
    v_exp_f32 v84, v84
    v_exp_f32 v85, v85
    v_mfma_f32_32x32x16_bf16 v[64:79], v[104:107], v[16:19], 0
    v_exp_f32 v86, v86
    v_exp_f32 v87, v87
    v_cvt_pk_bf16_f32 v96, v80, v81
    v_cvt_pk_bf16_f32 v97, v82, v83
    v_cvt_pk_bf16_f32 v98, v84, v85
    v_cvt_pk_bf16_f32 v99, v86, v87
    v_exp_f32 v88, v88
    v_exp_f32 v89, v89
    v_mfma_f32_32x32x16_bf16 v[144:159], v[108:111], v[96:99], v[144:159]
    v_exp_f32 v90, v90
    v_exp_f32 v91, v91
    v_exp_f32 v92, v92
    v_exp_f32 v93, v93
    v_exp_f32 v94, v94
    v_exp_f32 v95, v95
    v_cvt_pk_bf16_f32 v100, v88, v89
    v_cvt_pk_bf16_f32 v101, v90, v91
    v_cvt_pk_bf16_f32 v102, v92, v93
    v_cvt_pk_bf16_f32 v103, v94, v95
    v_exp_f32 v64, v64
    v_exp_f32 v65, v65
    v_exp_f32 v66, v66
    v_mfma_f32_32x32x16_bf16 v[144:159], v[112:115], v[100:103], v[144:159]
    v_exp_f32 v67, v67
    v_exp_f32 v68, v68
    v_exp_f32 v69, v69
    v_mfma_f32_32x32x16_bf16 v[80:95], v[104:107], v[20:23], 0
    v_exp_f32 v70, v70
    v_exp_f32 v71, v71
    v_cvt_pk_bf16_f32 v96, v64, v65
    v_cvt_pk_bf16_f32 v97, v66, v67
    v_cvt_pk_bf16_f32 v98, v68, v69
    v_cvt_pk_bf16_f32 v99, v70, v71
    v_exp_f32 v72, v72
    v_exp_f32 v73, v73
    v_mfma_f32_32x32x16_bf16 v[160:175], v[108:111], v[96:99], v[160:175]
    v_exp_f32 v74, v74
    v_exp_f32 v75, v75
    v_exp_f32 v76, v76
    v_exp_f32 v77, v77
    v_exp_f32 v78, v78
    v_exp_f32 v79, v79
    v_cvt_pk_bf16_f32 v100, v72, v73
    v_cvt_pk_bf16_f32 v101, v74, v75
    v_cvt_pk_bf16_f32 v102, v76, v77
    v_cvt_pk_bf16_f32 v103, v78, v79
    v_exp_f32 v80, v80
    v_exp_f32 v81, v81
    v_exp_f32 v82, v82
    v_mfma_f32_32x32x16_bf16 v[160:175], v[112:115], v[100:103], v[160:175]
    v_exp_f32 v83, v83
    v_exp_f32 v84, v84
    v_exp_f32 v85, v85
    v_mfma_f32_32x32x16_bf16 v[64:79], v[104:107], v[24:27], 0
    v_exp_f32 v86, v86
    v_exp_f32 v87, v87
    v_cvt_pk_bf16_f32 v96, v80, v81
    v_cvt_pk_bf16_f32 v97, v82, v83
    v_cvt_pk_bf16_f32 v98, v84, v85
    v_cvt_pk_bf16_f32 v99, v86, v87
    v_exp_f32 v88, v88
    v_exp_f32 v89, v89
    v_mfma_f32_32x32x16_bf16 v[176:191], v[108:111], v[96:99], v[176:191]
    v_exp_f32 v90, v90
    v_exp_f32 v91, v91
    v_exp_f32 v92, v92
    v_exp_f32 v93, v93
    v_exp_f32 v94, v94
    v_exp_f32 v95, v95
    v_cvt_pk_bf16_f32 v100, v88, v89
    v_cvt_pk_bf16_f32 v101, v90, v91
    v_cvt_pk_bf16_f32 v102, v92, v93
    v_cvt_pk_bf16_f32 v103, v94, v95
    v_exp_f32 v64, v64
    v_exp_f32 v65, v65
    v_exp_f32 v66, v66
    v_mfma_f32_32x32x16_bf16 v[176:191], v[112:115], v[100:103], v[176:191]
    v_exp_f32 v67, v67
    v_exp_f32 v68, v68
    v_exp_f32 v69, v69
    v_mfma_f32_32x32x16_bf16 v[80:95], v[104:107], v[28:31], 0
    v_exp_f32 v70, v70
    v_exp_f32 v71, v71
    v_cvt_pk_bf16_f32 v96, v64, v65
    v_cvt_pk_bf16_f32 v97, v66, v67
    v_cvt_pk_bf16_f32 v98, v68, v69
    v_cvt_pk_bf16_f32 v99, v70, v71
    v_exp_f32 v72, v72
    v_exp_f32 v73, v73
    v_mfma_f32_32x32x16_bf16 v[192:207], v[108:111], v[96:99], v[192:207]
    v_exp_f32 v74, v74
    v_exp_f32 v75, v75
    v_exp_f32 v76, v76
    v_exp_f32 v77, v77
    v_exp_f32 v78, v78
    v_exp_f32 v79, v79
    v_cvt_pk_bf16_f32 v100, v72, v73
    v_cvt_pk_bf16_f32 v101, v74, v75
    v_cvt_pk_bf16_f32 v102, v76, v77
    v_cvt_pk_bf16_f32 v103, v78, v79
    v_exp_f32 v80, v80
    v_exp_f32 v81, v81
    v_exp_f32 v82, v82
    v_mfma_f32_32x32x16_bf16 v[192:207], v[112:115], v[100:103], v[192:207]
    ds_read_b32 v5, v4 offset:20
    v_exp_f32 v83, v83
    v_exp_f32 v84, v84
    v_exp_f32 v85, v85
    v_mfma_f32_32x32x16_bf16 v[64:79], v[104:107], v[32:35], 0
    v_exp_f32 v86, v86
    v_exp_f32 v87, v87
    v_cvt_pk_bf16_f32 v96, v80, v81
    v_cvt_pk_bf16_f32 v97, v82, v83
    v_cvt_pk_bf16_f32 v98, v84, v85
    v_cvt_pk_bf16_f32 v99, v86, v87
    v_exp_f32 v88, v88
    v_exp_f32 v89, v89
    v_mfma_f32_32x32x16_bf16 v[208:223], v[108:111], v[96:99], v[208:223]
    v_exp_f32 v90, v90
    v_exp_f32 v91, v91
    v_exp_f32 v92, v92
    v_exp_f32 v93, v93
    v_exp_f32 v94, v94
    v_exp_f32 v95, v95
    v_cvt_pk_bf16_f32 v100, v88, v89
    v_cvt_pk_bf16_f32 v101, v90, v91
    v_cvt_pk_bf16_f32 v102, v92, v93
    v_cvt_pk_bf16_f32 v103, v94, v95
    v_exp_f32 v64, v64
    v_exp_f32 v65, v65
    v_exp_f32 v66, v66
    v_mfma_f32_32x32x16_bf16 v[208:223], v[112:115], v[100:103], v[208:223]
    s_waitcnt lgkmcnt(0)
    v_exp_f32 v67, v67
    v_exp_f32 v68, v68
    v_exp_f32 v69, v69
    v_mfma_f32_32x32x16_bf16 v[80:95], v[104:107], v[36:39], 0
    v_exp_f32 v70, v70
    v_exp_f32 v71, v71
    v_cvt_pk_bf16_f32 v96, v64, v65
    v_cvt_pk_bf16_f32 v97, v66, v67
    v_cvt_pk_bf16_f32 v98, v68, v69
    v_cvt_pk_bf16_f32 v99, v70, v71
    v_exp_f32 v72, v72
    v_exp_f32 v73, v73
    v_mfma_f32_32x32x16_bf16 v[224:239], v[108:111], v[96:99], v[224:239]
    v_exp_f32 v74, v74
    v_exp_f32 v75, v75
    v_exp_f32 v76, v76
    v_exp_f32 v77, v77
    v_exp_f32 v78, v78
    v_exp_f32 v79, v79
    v_cvt_pk_bf16_f32 v100, v72, v73
    v_cvt_pk_bf16_f32 v101, v74, v75
    v_cvt_pk_bf16_f32 v102, v76, v77
    v_cvt_pk_bf16_f32 v103, v78, v79
    v_exp_f32 v80, v80
    v_exp_f32 v81, v81
    v_exp_f32 v82, v82
    v_mfma_f32_32x32x16_bf16 v[224:239], v[112:115], v[100:103], v[224:239]
    s_waitcnt vmcnt(6)
    v_exp_f32 v83, v83
    v_exp_f32 v84, v84
    v_exp_f32 v85, v85
    v_mfma_f32_32x32x16_bf16 v[64:79], v[116:119], v[8:11], 0
    s_sub_u32 s64, s64, 1
    v_exp_f32 v86, v86
    v_exp_f32 v87, v87
    v_cvt_pk_bf16_f32 v96, v80, v81
    v_cvt_pk_bf16_f32 v97, v82, v83
    v_cvt_pk_bf16_f32 v98, v84, v85
    v_cvt_pk_bf16_f32 v99, v86, v87
    v_exp_f32 v88, v88
    v_exp_f32 v89, v89
    v_mfma_f32_32x32x16_bf16 v[240:255], v[108:111], v[96:99], v[240:255]
    s_cmp_lg_u32 s64, 0
    v_exp_f32 v90, v90
    v_exp_f32 v91, v91
    v_exp_f32 v92, v92
    v_exp_f32 v93, v93
    v_exp_f32 v94, v94
    v_exp_f32 v95, v95
    v_cvt_pk_bf16_f32 v100, v88, v89
    v_cvt_pk_bf16_f32 v101, v90, v91
    v_cvt_pk_bf16_f32 v102, v92, v93
    v_cvt_pk_bf16_f32 v103, v94, v95
    s_cbranch_scc1 L_attn_loop
    v_readfirstlane_b32 s8, v5
    s_nop 0
    s_cmp_ge_u32 s8, 4
    s_cbranch_scc0 L_xwait
L_xok:
    v_exp_f32 v64, v64
    v_exp_f32 v65, v65
    v_exp_f32 v66, v66
    v_mfma_f32_32x32x16_bf16 v[240:255], v[112:115], v[100:103], v[240:255]
    v_exp_f32 v67, v67
    v_exp_f32 v68, v68
    v_exp_f32 v69, v69
    v_mfma_f32_32x32x16_bf16 v[80:95], v[116:119], v[12:15], 0
    v_exp_f32 v70, v70
    v_exp_f32 v71, v71
    v_cvt_pk_bf16_f32 v96, v64, v65
    v_cvt_pk_bf16_f32 v97, v66, v67
    v_cvt_pk_bf16_f32 v98, v68, v69
    v_cvt_pk_bf16_f32 v99, v70, v71
    v_exp_f32 v72, v72
    v_exp_f32 v73, v73
    v_mfma_f32_32x32x16_bf16 v[128:143], v[120:123], v[96:99], v[128:143]
    v_exp_f32 v74, v74
    v_exp_f32 v75, v75
    v_exp_f32 v76, v76
    v_exp_f32 v77, v77
    v_exp_f32 v78, v78
    v_exp_f32 v79, v79
    v_cvt_pk_bf16_f32 v100, v72, v73
    v_cvt_pk_bf16_f32 v101, v74, v75
    v_cvt_pk_bf16_f32 v102, v76, v77
    v_cvt_pk_bf16_f32 v103, v78, v79
    v_exp_f32 v80, v80
    v_exp_f32 v81, v81
    v_exp_f32 v82, v82
    v_mfma_f32_32x32x16_bf16 v[128:143], v[124:127], v[100:103], v[128:143]
    v_exp_f32 v83, v83
    v_exp_f32 v84, v84
    v_exp_f32 v85, v85
    v_mfma_f32_32x32x16_bf16 v[64:79], v[116:119], v[16:19], 0
    v_exp_f32 v86, v86
    v_exp_f32 v87, v87
    v_cvt_pk_bf16_f32 v96, v80, v81
    v_cvt_pk_bf16_f32 v97, v82, v83
    v_cvt_pk_bf16_f32 v98, v84, v85
    v_cvt_pk_bf16_f32 v99, v86, v87
    v_exp_f32 v88, v88
    v_exp_f32 v89, v89
    v_mfma_f32_32x32x16_bf16 v[144:159], v[120:123], v[96:99], v[144:159]
    v_exp_f32 v90, v90
    v_exp_f32 v91, v91
    v_exp_f32 v92, v92
    v_exp_f32 v93, v93
    v_exp_f32 v94, v94
    v_exp_f32 v95, v95
    v_cvt_pk_bf16_f32 v100, v88, v89
    v_cvt_pk_bf16_f32 v101, v90, v91
    v_cvt_pk_bf16_f32 v102, v92, v93
    v_cvt_pk_bf16_f32 v103, v94, v95
    v_exp_f32 v64, v64
    v_exp_f32 v65, v65
    v_exp_f32 v66, v66
    v_mfma_f32_32x32x16_bf16 v[144:159], v[124:127], v[100:103], v[144:159]
    ds_write_b128 v6, v[128:131] offset:0
    v_exp_f32 v67, v67
    v_exp_f32 v68, v68
    v_exp_f32 v69, v69
    v_mfma_f32_32x32x16_bf16 v[80:95], v[116:119], v[20:23], 0
    ds_write_b128 v6, v[132:135] offset:1024
    v_exp_f32 v70, v70
    v_exp_f32 v71, v71
    v_cvt_pk_bf16_f32 v96, v64, v65
    v_cvt_pk_bf16_f32 v97, v66, v67
    v_cvt_pk_bf16_f32 v98, v68, v69
    v_cvt_pk_bf16_f32 v99, v70, v71
    v_exp_f32 v72, v72
    v_exp_f32 v73, v73
    v_mfma_f32_32x32x16_bf16 v[160:175], v[120:123], v[96:99], v[160:175]
    v_exp_f32 v74, v74
    v_exp_f32 v75, v75
    v_exp_f32 v76, v76
    v_exp_f32 v77, v77
    v_exp_f32 v78, v78
    v_exp_f32 v79, v79
    v_cvt_pk_bf16_f32 v100, v72, v73
    v_cvt_pk_bf16_f32 v101, v74, v75
    v_cvt_pk_bf16_f32 v102, v76, v77
    v_cvt_pk_bf16_f32 v103, v78, v79
    v_exp_f32 v80, v80
    v_exp_f32 v81, v81
    v_exp_f32 v82, v82
    v_mfma_f32_32x32x16_bf16 v[160:175], v[124:127], v[100:103], v[160:175]
    ds_write_b128 v6, v[144:147] offset:2048
    v_exp_f32 v83, v83
    v_exp_f32 v84, v84
    v_exp_f32 v85, v85
    v_mfma_f32_32x32x16_bf16 v[64:79], v[116:119], v[24:27], 0
    ds_write_b128 v6, v[148:151] offset:3072
    v_exp_f32 v86, v86
    v_exp_f32 v87, v87
    v_cvt_pk_bf16_f32 v96, v80, v81
    v_cvt_pk_bf16_f32 v97, v82, v83
    v_cvt_pk_bf16_f32 v98, v84, v85
    v_cvt_pk_bf16_f32 v99, v86, v87
    v_exp_f32 v88, v88
    v_exp_f32 v89, v89
    v_mfma_f32_32x32x16_bf16 v[176:191], v[120:123], v[96:99], v[176:191]
    ds_write2st64_b32 v7, v136, v152 offset0:0 offset1:1
    v_exp_f32 v90, v90
    v_exp_f32 v91, v91
    v_exp_f32 v92, v92
    v_exp_f32 v93, v93
    v_exp_f32 v94, v94
    v_exp_f32 v95, v95
    v_cvt_pk_bf16_f32 v100, v88, v89
    v_cvt_pk_bf16_f32 v101, v90, v91
    v_cvt_pk_bf16_f32 v102, v92, v93
    v_cvt_pk_bf16_f32 v103, v94, v95
    v_exp_f32 v64, v64
    v_exp_f32 v65, v65
    v_exp_f32 v66, v66
    v_mfma_f32_32x32x16_bf16 v[176:191], v[124:127], v[100:103], v[176:191]
    ds_write_b128 v6, v[160:163] offset:18432
    v_exp_f32 v67, v67
    v_exp_f32 v68, v68
    v_exp_f32 v69, v69
    v_mfma_f32_32x32x16_bf16 v[80:95], v[116:119], v[28:31], 0
    ds_write_b128 v6, v[164:167] offset:19456
    v_exp_f32 v70, v70
    v_exp_f32 v71, v71
    v_cvt_pk_bf16_f32 v96, v64, v65
    v_cvt_pk_bf16_f32 v97, v66, v67
    v_cvt_pk_bf16_f32 v98, v68, v69
    v_cvt_pk_bf16_f32 v99, v70, v71
    v_exp_f32 v72, v72
    v_exp_f32 v73, v73
    v_mfma_f32_32x32x16_bf16 v[192:207], v[120:123], v[96:99], v[192:207]
    v_exp_f32 v74, v74
    v_exp_f32 v75, v75
    v_exp_f32 v76, v76
    v_exp_f32 v77, v77
    v_exp_f32 v78, v78
    v_exp_f32 v79, v79
    v_cvt_pk_bf16_f32 v100, v72, v73
    v_cvt_pk_bf16_f32 v101, v74, v75
    v_cvt_pk_bf16_f32 v102, v76, v77
    v_cvt_pk_bf16_f32 v103, v78, v79
    v_exp_f32 v80, v80
    v_exp_f32 v81, v81
    v_exp_f32 v82, v82
    v_mfma_f32_32x32x16_bf16 v[192:207], v[124:127], v[100:103], v[192:207]
    ds_write_b128 v6, v[176:179] offset:20480
    v_exp_f32 v83, v83
    v_exp_f32 v84, v84
    v_exp_f32 v85, v85
    v_mfma_f32_32x32x16_bf16 v[64:79], v[116:119], v[32:35], 0
    ds_write_b128 v6, v[180:183] offset:21504
    v_exp_f32 v86, v86
    v_exp_f32 v87, v87
    v_cvt_pk_bf16_f32 v96, v80, v81
    v_cvt_pk_bf16_f32 v97, v82, v83
    v_cvt_pk_bf16_f32 v98, v84, v85
    v_cvt_pk_bf16_f32 v99, v86, v87
    v_exp_f32 v88, v88
    v_exp_f32 v89, v89
    v_mfma_f32_32x32x16_bf16 v[208:223], v[120:123], v[96:99], v[208:223]
    ds_write2st64_b32 v7, v168, v184 offset0:72 offset1:73
    v_exp_f32 v90, v90
    v_exp_f32 v91, v91
    v_exp_f32 v92, v92
    v_exp_f32 v93, v93
    v_exp_f32 v94, v94
    v_exp_f32 v95, v95
    v_cvt_pk_bf16_f32 v100, v88, v89
    v_cvt_pk_bf16_f32 v101, v90, v91
    v_cvt_pk_bf16_f32 v102, v92, v93
    v_cvt_pk_bf16_f32 v103, v94, v95
    v_exp_f32 v64, v64
    v_exp_f32 v65, v65
    v_exp_f32 v66, v66
    v_mfma_f32_32x32x16_bf16 v[208:223], v[124:127], v[100:103], v[208:223]
    ds_write_b128 v6, v[192:195] offset:36864
    v_exp_f32 v67, v67
    v_exp_f32 v68, v68
    v_exp_f32 v69, v69
    v_mfma_f32_32x32x16_bf16 v[80:95], v[116:119], v[36:39], 0
    ds_write_b128 v6, v[196:199] offset:37888
    v_exp_f32 v70, v70
    v_exp_f32 v71, v71
    v_cvt_pk_bf16_f32 v96, v64, v65
    v_cvt_pk_bf16_f32 v97, v66, v67
    v_cvt_pk_bf16_f32 v98, v68, v69
    v_cvt_pk_bf16_f32 v99, v70, v71
    v_exp_f32 v72, v72
    v_exp_f32 v73, v73
    v_mfma_f32_32x32x16_bf16 v[224:239], v[120:123], v[96:99], v[224:239]
    v_exp_f32 v74, v74
    v_exp_f32 v75, v75
    v_exp_f32 v76, v76
    v_exp_f32 v77, v77
    v_exp_f32 v78, v78
    v_exp_f32 v79, v79
    v_cvt_pk_bf16_f32 v100, v72, v73
    v_cvt_pk_bf16_f32 v101, v74, v75
    v_cvt_pk_bf16_f32 v102, v76, v77
    v_cvt_pk_bf16_f32 v103, v78, v79
    v_exp_f32 v80, v80
    v_exp_f32 v81, v81
    v_exp_f32 v82, v82
    v_mfma_f32_32x32x16_bf16 v[224:239], v[124:127], v[100:103], v[224:239]
    ds_write_b128 v6, v[208:211] offset:38912
    v_exp_f32 v83, v83
    v_exp_f32 v84, v84
    v_exp_f32 v85, v85
    ds_write_b128 v6, v[212:215] offset:39936
    v_exp_f32 v86, v86
    v_exp_f32 v87, v87
    v_cvt_pk_bf16_f32 v96, v80, v81
    v_cvt_pk_bf16_f32 v97, v82, v83
    v_cvt_pk_bf16_f32 v98, v84, v85
    v_cvt_pk_bf16_f32 v99, v86, v87
    v_exp_f32 v88, v88
    v_exp_f32 v89, v89
    v_mfma_f32_32x32x16_bf16 v[240:255], v[120:123], v[96:99], v[240:255]
    ds_write2st64_b32 v7, v200, v216 offset0:144 offset1:145
    v_exp_f32 v90, v90
    v_exp_f32 v91, v91
    v_exp_f32 v92, v92
    v_exp_f32 v93, v93
    v_exp_f32 v94, v94
    v_exp_f32 v95, v95
    v_cvt_pk_bf16_f32 v100, v88, v89
    v_cvt_pk_bf16_f32 v101, v90, v91
    v_cvt_pk_bf16_f32 v102, v92, v93
    v_cvt_pk_bf16_f32 v103, v94, v95
    v_add_u32 v104, s82, v2
    v_add_u32 v105, s83, v2
    v_mfma_f32_32x32x16_bf16 v[240:255], v[124:127], v[100:103], v[240:255]
    v_add_u32 v106, s84, v2
    v_lshlrev_b32 v110, 2, v0
    v_add_u32 v107, s82, v110
    v_add_u32 v108, s83, v110
    v_add_u32 v109, s84, v110
    v_and_b32 v110, 124, v110
    v_add_u32 v110, 151552, v110
    s_waitcnt lgkmcnt(0)
    s_barrier
    s_setprio 3
    ds_read_b128 v[128:131], v104 offset:0
    ds_read_b128 v[132:135], v104 offset:1024
    ds_read_b128 v[144:147], v105 offset:0
    ds_read_b128 v[148:151], v105 offset:1024
    ds_read_b128 v[160:163], v106 offset:0
    ds_read_b128 v[164:167], v106 offset:1024
    ds_read2st64_b32 v[218:219], v107 offset0:16 offset1:17
    ds_read2st64_b32 v[220:221], v108 offset0:16 offset1:17
    ds_read2st64_b32 v[222:223], v109 offset0:16 offset1:17
    ds_read2_b32 v[4:5], v110 offset0:0 offset1:32
    ds_read_b128 v[176:179], v104 offset:2048
    ds_read_b128 v[180:183], v104 offset:3072
    ds_read_b128 v[192:195], v105 offset:2048
    ds_read_b128 v[196:199], v105 offset:3072
    ds_read_b128 v[208:211], v106 offset:2048
    ds_read_b128 v[212:215], v106 offset:3072
    s_waitcnt lgkmcnt(12)
    v_pk_add_f32 v[128:129], v[128:129], v[144:145]
    v_pk_add_f32 v[130:131], v[130:131], v[146:147]
    v_pk_add_f32 v[132:133], v[132:133], v[148:149]
    v_pk_add_f32 v[134:135], v[134:135], v[150:151]
    s_waitcnt lgkmcnt(10)
    v_pk_add_f32 v[224:225], v[224:225], v[160:161]
    v_pk_add_f32 v[226:227], v[226:227], v[162:163]
    v_pk_add_f32 v[228:229], v[228:229], v[164:165]
    v_pk_add_f32 v[230:231], v[230:231], v[166:167]
    s_waitcnt lgkmcnt(6)
    v_pk_add_f32 v[218:219], v[218:219], v[220:221]
    v_pk_add_f32 v[218:219], v[218:219], v[222:223]
    v_add_f32 v232, v232, v218
    v_pk_add_f32 v[224:225], v[224:225], v[128:129]
    v_pk_add_f32 v[226:227], v[226:227], v[130:131]
    v_pk_add_f32 v[228:229], v[228:229], v[132:133]
    v_pk_add_f32 v[230:231], v[230:231], v[134:135]
    v_pk_mul_f32 v[6:7], v[224:225], 0 op_sel_hi:[1,0]
    v_cmp_le_f32 s[54:55], s80, v232
    v_cmp_ge_f32 s[56:57], s81, v232
    v_pk_fma_f32 v[6:7], v[226:227], 0, v[6:7] op_sel_hi:[1,0,1]
    v_pk_fma_f32 v[6:7], v[228:229], 0, v[6:7] op_sel_hi:[1,0,1]
    v_pk_fma_f32 v[6:7], v[230:231], 0, v[6:7] op_sel_hi:[1,0,1]
    s_and_b64 s[54:55], s[54:55], s[56:57]
    v_cmp_o_f32 vcc, v6, v7
    v_rcp_f32 v6, v232
    s_and_b64 s[54:55], s[54:55], vcc
    s_cmp_eq_u64 s[54:55], -1
    s_cbranch_scc0 L_slow0
L_ok0:
    v_mul_f32 v6, v6, v4
    v_pk_mul_f32 v[224:225], v[224:225], v[6:7] op_sel_hi:[1,0]
    v_pk_mul_f32 v[226:227], v[226:227], v[6:7] op_sel_hi:[1,0]
    v_pk_mul_f32 v[228:229], v[228:229], v[6:7] op_sel_hi:[1,0]
    v_pk_mul_f32 v[230:231], v[230:231], v[6:7] op_sel_hi:[1,0]
    v_cvt_pk_bf16_f32 v64, v224, v225
    v_cvt_pk_bf16_f32 v65, v226, v227
    v_cvt_pk_bf16_f32 v66, v228, v229
    v_cvt_pk_bf16_f32 v67, v230, v231
    v_min_u32 v64, -2, v64
    buffer_store_dwordx4 v[64:67], v2, s[68:71], s53 offen offset:0 sc1
    s_waitcnt lgkmcnt(2)
    v_pk_add_f32 v[176:177], v[176:177], v[192:193]
    v_pk_add_f32 v[178:179], v[178:179], v[194:195]
    v_pk_add_f32 v[180:181], v[180:181], v[196:197]
    v_pk_add_f32 v[182:183], v[182:183], v[198:199]
    s_waitcnt lgkmcnt(0)
    v_pk_add_f32 v[240:241], v[240:241], v[208:209]
    v_pk_add_f32 v[242:243], v[242:243], v[210:211]
    v_pk_add_f32 v[244:245], v[244:245], v[212:213]
    v_pk_add_f32 v[246:247], v[246:247], v[214:215]
    v_add_f32 v248, v248, v219
    v_pk_add_f32 v[240:241], v[240:241], v[176:177]
    v_pk_add_f32 v[242:243], v[242:243], v[178:179]
    v_pk_add_f32 v[244:245], v[244:245], v[180:181]
    v_pk_add_f32 v[246:247], v[246:247], v[182:183]
    v_pk_mul_f32 v[6:7], v[240:241], 0 op_sel_hi:[1,0]
    v_cmp_le_f32 s[54:55], s80, v248
    v_cmp_ge_f32 s[56:57], s81, v248
    v_pk_fma_f32 v[6:7], v[242:243], 0, v[6:7] op_sel_hi:[1,0,1]
    v_pk_fma_f32 v[6:7], v[244:245], 0, v[6:7] op_sel_hi:[1,0,1]
    v_pk_fma_f32 v[6:7], v[246:247], 0, v[6:7] op_sel_hi:[1,0,1]
    s_and_b64 s[54:55], s[54:55], s[56:57]
    v_cmp_o_f32 vcc, v6, v7
    v_rcp_f32 v6, v248
    s_and_b64 s[54:55], s[54:55], vcc
    s_cmp_eq_u64 s[54:55], -1
    s_cbranch_scc0 L_slow1
L_ok1:
    v_mul_f32 v6, v6, v5
    v_pk_mul_f32 v[240:241], v[240:241], v[6:7] op_sel_hi:[1,0]
    v_pk_mul_f32 v[242:243], v[242:243], v[6:7] op_sel_hi:[1,0]
    v_pk_mul_f32 v[244:245], v[244:245], v[6:7] op_sel_hi:[1,0]
    v_pk_mul_f32 v[246:247], v[246:247], v[6:7] op_sel_hi:[1,0]
    v_cvt_pk_bf16_f32 v68, v240, v241
    v_cvt_pk_bf16_f32 v69, v242, v243
    v_cvt_pk_bf16_f32 v70, v244, v245
    v_cvt_pk_bf16_f32 v71, v246, v247
    v_min_u32 v68, -2, v68
    buffer_store_dwordx4 v[68:71], v2, s[68:71], s53 offen offset:1024 sc1
    s_barrier
    s_setprio 0
    v_lshrrev_b32 v10, 3, v0
    s_lshl_b32 s10, s3, 3
    v_add_u32 v10, s10, v10
    v_and_b32 v11, 7, v0
    v_mul_u32_u24 v8, 272, v10
    v_lshl_add_u32 v8, v11, 5, v8
    v_add_u32 v8, 65536, v8
    v_add_u32 v9, 34816, v8
    v_lshlrev_b32 v10, 10, v10
    v_lshl_add_u32 v10, v11, 4, v10
    s_lshl_b32 s10, s4, 16
    s_lshl_b32 s11, s5, 7
    s_add_u32 s10, s10, s11
    s_mov_b32 s84, s38
    s_mov_b32 s85, s39
    s_mov_b32 s86, 0x200000
    s_mov_b32 s87, 0x20000
    s_waitcnt vmcnt(0)
    s_barrier
    ds_read_b128 v[12:15], v8 offset:0
    ds_read_b128 v[16:19], v8 offset:16
    ds_read_b128 v[20:23], v8 offset:17408
    ds_read_b128 v[24:27], v8 offset:17424
    ds_read_b128 v[28:31], v9 offset:0
    ds_read_b128 v[32:35], v9 offset:16
    ds_read_b128 v[36:39], v9 offset:17408
    ds_read_b128 v[40:43], v9 offset:17424
    s_waitcnt lgkmcnt(4)
    v_pk_add_f32 v[12:13], v[12:13], v[20:21]
    v_pk_add_f32 v[14:15], v[14:15], v[22:23]
    v_pk_add_f32 v[16:17], v[16:17], v[24:25]
    v_pk_add_f32 v[18:19], v[18:19], v[26:27]
    s_waitcnt lgkmcnt(0)
    v_pk_add_f32 v[28:29], v[28:29], v[36:37]
    v_pk_add_f32 v[30:31], v[30:31], v[38:39]
    v_pk_add_f32 v[32:33], v[32:33], v[40:41]
    v_pk_add_f32 v[34:35], v[34:35], v[42:43]
    v_pk_add_f32 v[12:13], v[12:13], v[28:29]
    v_pk_add_f32 v[14:15], v[14:15], v[30:31]
    v_pk_add_f32 v[16:17], v[16:17], v[32:33]
    v_pk_add_f32 v[18:19], v[18:19], v[34:35]
    v_cvt_pk_bf16_f32 v20, v12, v13
    v_cvt_pk_bf16_f32 v21, v14, v15
    v_cvt_pk_bf16_f32 v22, v16, v17
    v_cvt_pk_bf16_f32 v23, v18, v19
    buffer_store_dwordx4 v[20:23], v10, s[84:87], s10 offen
    s_endpgm
L_kvr_first:
    s_sub_u32 s65, s65, 1
    s_cmp_le_i32 s65, 0
    s_cbranch_scc1 L_kv_first_ok
    s_waitcnt vmcnt(0)
    buffer_load_dwordx4 v[40:43], v2, s[76:79], s66 offen offset:0 sc1
    buffer_load_dwordx4 v[44:47], v3, s[76:79], s66 offen offset:1024 sc1
    buffer_load_dwordx4 v[48:51], v1, s[76:79], s66 offen offset:1024 sc1
    buffer_load_dword v117, v116, s[68:71], s66 offen sc1
    buffer_load_dwordx4 v[52:55], v2, s[76:79], s66 offen offset:2304 sc1
    buffer_load_dwordx4 v[56:59], v3, s[76:79], s66 offen offset:3328 sc1
    buffer_load_dwordx4 v[60:63], v1, s[76:79], s66 offen offset:3328 sc1
    buffer_load_dwordx4 v[104:107], v2, s[76:79], s62 offen offset:0 sc1
    buffer_load_dwordx4 v[108:111], v3, s[76:79], s62 offen offset:1024 sc1
    buffer_load_dwordx4 v[112:115], v1, s[76:79], s62 offen offset:1024 sc1
    s_waitcnt vmcnt(0)
    v_max3_u32 v6, v40, v44, v48
    v_max3_u32 v7, v52, v56, v60
    v_max3_u32 v6, v6, v104, v108
    v_max3_u32 v6, v6, v7, v112
    v_max_u32 v6, v6, v117
    v_cmp_eq_u32 vcc, -1, v6
    s_cbranch_vccz L_kv_first_ok
    s_branch L_kvr_first
L_tagr:
    s_sleep 4
    buffer_load_dword v5, v4, s[68:71], s66 offen sc1
    s_waitcnt vmcnt(0)
    v_cmp_ne_u32 vcc, s59, v5
    s_cbranch_vccz L_tag_ok
    s_sub_u32 s65, s65, 1
    s_cmp_le_i32 s65, 0
    s_cbranch_scc1 L_tag_ok
    s_branch L_tagr
L_xwait:
    ds_read_b32 v5, v4 offset:20
    s_waitcnt lgkmcnt(0)
    v_readfirstlane_b32 s8, v5
    s_nop 0
    s_cmp_ge_u32 s8, 4
    s_cbranch_scc0 L_xwait
    s_branch L_xok
L_k1:
    ds_read_b32 v6, v93 offset:4
    s_waitcnt lgkmcnt(0)
    v_readfirstlane_b32 s8, v6
    s_nop 0
    s_cmp_ge_u32 s8, 3
    s_cbranch_scc0 L_k1
    s_branch L_k1_ok
L_k2:
    ds_read_b32 v6, v93 offset:8
    s_waitcnt lgkmcnt(0)
    v_readfirstlane_b32 s8, v6
    s_nop 0
    s_cmp_ge_u32 s8, 3
    s_cbranch_scc0 L_k2
    s_branch L_k2_ok
L_k3:
    ds_read_b32 v6, v93 offset:12
    s_waitcnt lgkmcnt(0)
    v_readfirstlane_b32 s8, v6
    s_nop 0
    s_cmp_ge_u32 s8, 4
    s_cbranch_scc0 L_k3
    s_branch L_k3_ok
L_G123:
    s_waitcnt lgkmcnt(0)
    s_mov_b32 s44, s16
    s_mov_b32 s45, s17
    s_mov_b32 s46, 0x200000
    s_mov_b32 s47, 0x20000
    s_mov_b32 s68, s42
    s_mov_b32 s69, s43
    s_mov_b32 s70, 0x940000
    s_mov_b32 s71, 0x20000
    s_mov_b32 s56, s28
    s_mov_b32 s57, s29
    s_mov_b32 s58, 0x1c0000
    s_mov_b32 s59, 0x20000
    s_mov_b32 s60, s30
    s_mov_b32 s61, s31
    s_mov_b32 s62, 0xe00
    s_mov_b32 s63, 0x20000
    v_lshrrev_b32 v14, 3, v0
    v_mul_u32_u24 v4, 3584, v14
    v_bfe_u32 v14, v0, 4, 1
    v_lshlrev_b32 v14, 2, v14
    v_xor_b32 v14, v14, v0
    v_and_b32 v14, 7, v14
    v_lshl_add_u32 v4, v14, 4, v4
    v_add_u32 v5, 27648, v4
    v_lshrrev_b32 v14, 3, v0
    v_mul_u32_u24 v6, 1024, v14
    v_bfe_u32 v14, v0, 4, 1
    v_lshlrev_b32 v14, 2, v14
    v_xor_b32 v14, v14, v0
    v_and_b32 v14, 7, v14
    v_lshl_add_u32 v6, v14, 4, v6
    v_add_u32 v7, 7168, v6
    s_and_b32 s12, s5, 3
    s_mul_i32 s12, s12, 7
    s_lshr_b32 s9, s5, 2
    s_lshl_b32 s9, s9, 2
    s_add_u32 s13, s9, s6
    s_add_u32 s12, s12, s13
    s_lshl_b32 s12, s12, 7
    s_add_u32 s77, s12, 1835008
    s_mul_i32 s76, s15, 229376
    s_add_u32 s76, s76, s12
    v_lshlrev_b32 v14, 1, v0
    v_cmp_gt_u32 vcc, 32, v0
    v_mov_b32 v15, 0x40000000
    v_mov_b32 v12, 151808
    v_cndmask_b32 v11, v15, v14, vcc
    v_mov_b32 v15, 0x3f80
    v_cndmask_b32 v28, 0, v15, vcc
    v_mov_b32 v21, 0
    v_mov_b32 v22, 0
    v_mov_b32 v23, 0
    v_mov_b32 v25, 0
    v_mov_b32 v26, 0
    v_mov_b32 v27, 0
    v_mov_b32 v29, 0
    v_mov_b32 v30, 0
    v_mov_b32 v31, 0
    v_bfe_u32 v14, v0, 1, 3
    v_lshrrev_b32 v15, 5, v0
    v_xor_b32 v14, v14, v15
    v_and_b32 v15, 31, v0
    v_lshlrev_b32 v15, 7, v15
    v_xor_b32 v16, 0, v14
    v_lshl_add_u32 v16, v16, 4, v15
    v_xor_b32 v17, 2, v14
    v_lshl_add_u32 v17, v17, 4, v15
    v_xor_b32 v18, 4, v14
    v_lshl_add_u32 v18, v18, 4, v15
    v_xor_b32 v19, 6, v14
    v_lshl_add_u32 v19, v19, 4, v15
    v_lshrrev_b32 v14, 5, v0
    v_mul_u32_u24 v14, 8, v14
    v_bfe_u32 v15, v0, 2, 2
    v_add_u32 v14, v14, v15
    v_lshlrev_b32 v224, 7, v14
    v_and_b32 v15, 3, v0
    v_lshl_add_u32 v224, v15, 3, v224
    v_bfe_u32 v15, v0, 4, 1
    v_lshl_add_u32 v224, v15, 5, v224
    v_bfe_u32 v15, v0, 3, 1
    v_lshl_add_u32 v224, v15, 6, v224
    v_lshrrev_b32 v14, 5, v0
    v_mul_u32_u24 v14, 4, v14
    v_bfe_u32 v15, v0, 2, 2
    v_add_u32 v14, v14, v15
    v_lshlrev_b32 v226, 7, v14
    v_and_b32 v15, 3, v0
    v_lshl_add_u32 v226, v15, 3, v226
    v_bfe_u32 v15, v0, 4, 1
    v_lshl_add_u32 v226, v15, 5, v226
    v_bfe_u32 v15, v0, 3, 1
    v_lshl_add_u32 v226, v15, 6, v226
    s_lshl_b32 s8, s6, 11
    s_add_u32 s8, s8, 135168
    v_add_u32 v3, s8, v2
    v_add_u32 v228, s8, v224
    s_mul_i32 s14, s6, 17408
    s_add_u32 s14, s14, 65536
    v_add_u32 v224, s14, v224
    v_add_u32 v226, s14, v226
    v_xor_b32 v225, 64, v224
    v_xor_b32 v227, 64, v226
    v_xor_b32 v229, 64, v228
    v_mov_b32 v8, 1
    s_mov_b32 s48, s18
    s_mov_b32 s49, s19
    s_mov_b32 s50, 0x80000
    s_mov_b32 s51, 0x20000
    s_mov_b32 s99, 8000
    s_add_u32 s8, s6, -1
    s_min_u32 s8, s8, 7
    s_lshl_b32 s52, s8, 11
    s_add_u32 s52, s52, 65536
    s_lshl_b32 s8, s8, 14
    s_lshl_b32 s9, s15, 16
    s_add_u32 s8, s8, s9
    s_lshl_b32 s9, s5, 7
    s_add_u32 s64, s8, s9
    s_add_u32 s8, s6, 2
    s_min_u32 s8, s8, 7
    s_lshl_b32 s53, s8, 11
    s_add_u32 s53, s53, 65536
    s_lshl_b32 s8, s8, 14
    s_lshl_b32 s9, s15, 16
    s_add_u32 s8, s8, s9
    s_lshl_b32 s9, s5, 7
    s_add_u32 s65, s8, s9
    s_add_u32 s8, s6, 5
    s_min_u32 s8, s8, 7
    s_lshl_b32 s54, s8, 11
    s_add_u32 s54, s54, 65536
    s_lshl_b32 s8, s8, 14
    s_lshl_b32 s9, s15, 16
    s_add_u32 s8, s8, s9
    s_lshl_b32 s9, s5, 7
    s_add_u32 s66, s8, s9
    s_waitcnt lgkmcnt(0)
    s_barrier
    s_add_u32 m0, s10, 0
    s_nop 0
    buffer_load_dwordx4 v9, s[44:47], s11 offen lds
    buffer_load_dwordx4 v10, s[44:47], s11 offen offset:1024 lds
    s_add_u32 m0, s10, 8192
    s_add_u32 s11, s11, 128
    s_and_b32 s11, s11, 0x380
    buffer_load_dwordx4 v9, s[44:47], s11 offen lds
    buffer_load_dwordx4 v10, s[44:47], s11 offen offset:1024 lds
    s_add_u32 m0, s10, 16384
    s_add_u32 s11, s11, 128
    s_and_b32 s11, s11, 0x380
    buffer_load_dwordx4 v9, s[44:47], s11 offen lds
    buffer_load_dwordx4 v10, s[44:47], s11 offen offset:1024 lds
    s_add_u32 m0, s10, 24576
    s_add_u32 s11, s11, 128
    s_and_b32 s11, s11, 0x380
    buffer_load_dwordx4 v9, s[44:47], s11 offen lds
    buffer_load_dwordx4 v10, s[44:47], s11 offen offset:1024 lds
    s_add_u32 s8, s64, 131072
    s_add_u32 m0, s52, 16384
    s_and_b32 s8, s8, 0x7ffff
    buffer_load_dwordx4 v6, s[48:51], s8 offen lds
    buffer_load_dwordx4 v7, s[48:51], s8 offen offset:1024 lds
    s_add_u32 s8, s65, 131072
    s_add_u32 m0, s53, 16384
    s_and_b32 s8, s8, 0x7ffff
    buffer_load_dwordx4 v6, s[48:51], s8 offen lds
    buffer_load_dwordx4 v7, s[48:51], s8 offen offset:1024 lds
    s_add_u32 s8, s66, 131072
    s_add_u32 m0, s54, 16384
    s_and_b32 s8, s8, 0x7ffff
    buffer_load_dwordx4 v6, s[48:51], s8 offen lds
    buffer_load_dwordx4 v7, s[48:51], s8 offen offset:1024 lds
    s_waitcnt vmcnt(10)
    s_mov_b64 exec, 1
    ds_add_u32 v12, v8 offset:0
    s_mov_b64 exec, -1
    s_add_u32 m0, s10, 32768
    s_add_u32 s11, s11, 128
    s_and_b32 s11, s11, 0x380
    buffer_load_dwordx4 v9, s[44:47], s11 offen lds
    buffer_load_dwordx4 v10, s[44:47], s11 offen offset:1024 lds
    s_add_u32 m0, s10, 40960
    s_add_u32 s11, s11, 128
    s_and_b32 s11, s11, 0x380
    buffer_load_dwordx4 v9, s[44:47], s11 offen lds
    buffer_load_dwordx4 v10, s[44:47], s11 offen offset:1024 lds
    s_add_u32 s8, s64, 262144
    s_add_u32 m0, s52, 32768
    s_and_b32 s8, s8, 0x7ffff
    buffer_load_dwordx4 v6, s[48:51], s8 offen lds
    buffer_load_dwordx4 v7, s[48:51], s8 offen offset:1024 lds
    s_add_u32 s8, s65, 262144
    s_add_u32 m0, s53, 32768
    s_and_b32 s8, s8, 0x7ffff
    buffer_load_dwordx4 v6, s[48:51], s8 offen lds
    buffer_load_dwordx4 v7, s[48:51], s8 offen offset:1024 lds
    s_add_u32 s8, s66, 262144
    s_add_u32 m0, s54, 32768
    s_and_b32 s8, s8, 0x7ffff
    buffer_load_dwordx4 v6, s[48:51], s8 offen lds
    buffer_load_dwordx4 v7, s[48:51], s8 offen offset:1024 lds
    s_waitcnt vmcnt(10)
    s_mov_b64 exec, 1
    ds_add_u32 v12, v8 offset:4
    s_mov_b64 exec, -1
    s_add_u32 m0, s10, 49152
    s_add_u32 s11, s11, 128
    s_and_b32 s11, s11, 0x380
    buffer_load_dwordx4 v9, s[44:47], s11 offen lds
    buffer_load_dwordx4 v10, s[44:47], s11 offen offset:1024 lds
    s_add_u32 m0, s10, 57344
    s_add_u32 s11, s11, 128
    s_and_b32 s11, s11, 0x380
    buffer_load_dwordx4 v9, s[44:47], s11 offen lds
    buffer_load_dwordx4 v10, s[44:47], s11 offen offset:1024 lds
    s_add_u32 s8, s64, 393216
    s_add_u32 m0, s52, 49152
    s_and_b32 s8, s8, 0x7ffff
    buffer_load_dwordx4 v6, s[48:51], s8 offen lds
    buffer_load_dwordx4 v7, s[48:51], s8 offen offset:1024 lds
    s_add_u32 s8, s65, 393216
    s_add_u32 m0, s53, 49152
    s_and_b32 s8, s8, 0x7ffff
    buffer_load_dwordx4 v6, s[48:51], s8 offen lds
    buffer_load_dwordx4 v7, s[48:51], s8 offen offset:1024 lds
    s_add_u32 s8, s66, 393216
    s_add_u32 m0, s54, 49152
    s_and_b32 s8, s8, 0x7ffff
    buffer_load_dwordx4 v6, s[48:51], s8 offen lds
    buffer_load_dwordx4 v7, s[48:51], s8 offen offset:1024 lds
    s_waitcnt vmcnt(10)
    s_mov_b64 exec, 1
    ds_add_u32 v12, v8 offset:8
    s_mov_b64 exec, -1
    s_waitcnt vmcnt(0)
    s_mov_b64 exec, 1
    ds_add_u32 v12, v8 offset:12
    s_mov_b64 exec, -1
L_G_ffn1:
L_G_xw:
    s_sleep 2
    ds_read_b128 v[32:35], v12
    s_waitcnt lgkmcnt(0)
    v_add_u32 v32, -5, v32
    v_add_u32 v35, -1, v35
    v_min3_i32 v33, v33, v34, v35
    v_min_i32 v32, v32, v33
    s_nop 0
    v_readfirstlane_b32 s8, v32
    s_nop 0
    s_cmp_ge_i32 s8, 3
    s_cbranch_scc0 L_G_xw
    v_bfe_u32 v14, v0, 4, 2
    v_and_b32 v15, 7, v0
    v_xor_b32 v14, v14, v15
    s_and_b32 s8, s6, 1
    s_lshl_b32 s8, s8, 2
    v_xor_b32 v14, s8, v14
    v_lshlrev_b32 v14, 4, v14
    v_add_u32 v99, 152576, v14
    s_setprio 0
    ds_read_b128 v[64:67], v99 offset:0
    ds_read_b128 v[68:71], v99 offset:128
    ds_read_b128 v[72:75], v99 offset:256
    ds_read_b128 v[76:79], v99 offset:384
    ds_read_b128 v[80:83], v99 offset:512
    ds_read_b128 v[84:87], v99 offset:640
    ds_read_b128 v[88:91], v99 offset:768
    ds_read_b128 v[92:95], v99 offset:896
    s_waitcnt lgkmcnt(0)
    s_lshl_b32 s8, s6, 10
    v_add_u32 v98, s8, v2
    v_mov_b32 v96, 0
    v_mov_b32 v97, 0
    ds_read_b128 v[32:35], v98 offset:0
    ds_read_b128 v[36:39], v98 offset:4096
    ds_read_b128 v[40:43], v98 offset:8192
    ds_read_b128 v[44:47], v98 offset:12288
    ds_read_b128 v[48:51], v98 offset:16384
    ds_read_b128 v[52:55], v98 offset:20480
    s_waitcnt lgkmcnt(4)
    v_dot2_f32_bf16 v96, v32, v64, v96
    v_dot2_f32_bf16 v97, v36, v64, v97
    v_dot2_f32_bf16 v96, v33, v65, v96
    v_dot2_f32_bf16 v97, v37, v65, v97
    v_dot2_f32_bf16 v96, v34, v66, v96
    v_dot2_f32_bf16 v97, v38, v66, v97
    v_dot2_f32_bf16 v96, v35, v67, v96
    v_dot2_f32_bf16 v97, v39, v67, v97
    ds_read_b128 v[32:35], v98 offset:24576
    ds_read_b128 v[36:39], v98 offset:28672
    s_waitcnt lgkmcnt(4)
    v_dot2_f32_bf16 v96, v40, v68, v96
    v_dot2_f32_bf16 v97, v44, v68, v97
    v_dot2_f32_bf16 v96, v41, v69, v96
    v_dot2_f32_bf16 v97, v45, v69, v97
    v_dot2_f32_bf16 v96, v42, v70, v96
    v_dot2_f32_bf16 v97, v46, v70, v97
    v_dot2_f32_bf16 v96, v43, v71, v96
    v_dot2_f32_bf16 v97, v47, v71, v97
    ds_read_b128 v[40:43], v98 offset:32768
    ds_read_b128 v[44:47], v98 offset:36864
    s_waitcnt lgkmcnt(4)
    v_dot2_f32_bf16 v96, v48, v72, v96
    v_dot2_f32_bf16 v97, v52, v72, v97
    v_dot2_f32_bf16 v96, v49, v73, v96
    v_dot2_f32_bf16 v97, v53, v73, v97
    v_dot2_f32_bf16 v96, v50, v74, v96
    v_dot2_f32_bf16 v97, v54, v74, v97
    v_dot2_f32_bf16 v96, v51, v75, v96
    v_dot2_f32_bf16 v97, v55, v75, v97
    ds_read_b128 v[48:51], v98 offset:40960
    ds_read_b128 v[52:55], v98 offset:45056
    s_waitcnt lgkmcnt(4)
    v_dot2_f32_bf16 v96, v32, v76, v96
    v_dot2_f32_bf16 v97, v36, v76, v97
    v_dot2_f32_bf16 v96, v33, v77, v96
    v_dot2_f32_bf16 v97, v37, v77, v97
    v_dot2_f32_bf16 v96, v34, v78, v96
    v_dot2_f32_bf16 v97, v38, v78, v97
    v_dot2_f32_bf16 v96, v35, v79, v96
    v_dot2_f32_bf16 v97, v39, v79, v97
    ds_read_b128 v[32:35], v98 offset:49152
    ds_read_b128 v[36:39], v98 offset:53248
    s_waitcnt lgkmcnt(4)
    v_dot2_f32_bf16 v96, v40, v80, v96
    v_dot2_f32_bf16 v97, v44, v80, v97
    v_dot2_f32_bf16 v96, v41, v81, v96
    v_dot2_f32_bf16 v97, v45, v81, v97
    v_dot2_f32_bf16 v96, v42, v82, v96
    v_dot2_f32_bf16 v97, v46, v82, v97
    v_dot2_f32_bf16 v96, v43, v83, v96
    v_dot2_f32_bf16 v97, v47, v83, v97
    ds_read_b128 v[40:43], v98 offset:57344
    ds_read_b128 v[44:47], v98 offset:61440
    s_waitcnt lgkmcnt(4)
    v_dot2_f32_bf16 v96, v48, v84, v96
    v_dot2_f32_bf16 v97, v52, v84, v97
    v_dot2_f32_bf16 v96, v49, v85, v96
    v_dot2_f32_bf16 v97, v53, v85, v97
    v_dot2_f32_bf16 v96, v50, v86, v96
    v_dot2_f32_bf16 v97, v54, v86, v97
    v_dot2_f32_bf16 v96, v51, v87, v96
    v_dot2_f32_bf16 v97, v55, v87, v97
    s_waitcnt lgkmcnt(2)
    v_dot2_f32_bf16 v96, v32, v88, v96
    v_dot2_f32_bf16 v97, v36, v88, v97
    v_dot2_f32_bf16 v96, v33, v89, v96
    v_dot2_f32_bf16 v97, v37, v89, v97
    v_dot2_f32_bf16 v96, v34, v90, v96
    v_dot2_f32_bf16 v97, v38, v90, v97
    v_dot2_f32_bf16 v96, v35, v91, v96
    v_dot2_f32_bf16 v97, v39, v91, v97
    s_waitcnt lgkmcnt(0)
    v_dot2_f32_bf16 v96, v40, v92, v96
    v_dot2_f32_bf16 v97, v44, v92, v97
    v_dot2_f32_bf16 v96, v41, v93, v96
    v_dot2_f32_bf16 v97, v45, v93, v97
    v_dot2_f32_bf16 v96, v42, v94, v96
    v_dot2_f32_bf16 v97, v46, v94, v97
    v_dot2_f32_bf16 v96, v43, v95, v96
    v_dot2_f32_bf16 v97, v47, v95, v97
    v_lshrrev_b32 v98, 3, v0
    s_lshl_b32 s9, s6, 5
    s_add_u32 s9, s9, 151552
    v_add_f32_dpp v96, v96, v96 quad_perm:[1,0,3,2] row_mask:0xf bank_mask:0xf
    v_add_f32_dpp v97, v97, v97 quad_perm:[1,0,3,2] row_mask:0xf bank_mask:0xf
    s_nop 0
    v_add_f32_dpp v96, v96, v96 quad_perm:[2,3,0,1] row_mask:0xf bank_mask:0xf
    v_add_f32_dpp v97, v97, v97 quad_perm:[2,3,0,1] row_mask:0xf bank_mask:0xf
    s_nop 0
    v_add_f32_dpp v96, v96, v96 row_half_mirror row_mask:0xf bank_mask:0xf
    v_add_f32_dpp v97, v97, v97 row_half_mirror row_mask:0xf bank_mask:0xf
    s_mov_b32 s10, 0xbfb8aa3b
    v_mul_f32 v96, s10, v96
    v_mul_f32 v97, s10, v97
    v_exp_f32 v96, v96
    v_exp_f32 v97, v97
    v_lshl_add_u32 v98, v98, 2, s9
    v_add_f32 v96, 1.0, v96
    v_add_f32 v97, 1.0, v97
    v_rcp_f32 v96, v96
    v_rcp_f32 v97, v97
    s_nop 0
    ds_write_b32 v98, v96 offset:0
    ds_write_b32 v98, v97 offset:128
    s_waitcnt lgkmcnt(0)
    s_setprio 2
    s_cmp_eq_u32 s13, 7
    s_cbranch_scc1 L_G_idle
L_G_kw:
    s_sleep 2
L_G_kw1:
    ds_read_b32 v14, v12 offset:28
    s_waitcnt lgkmcnt(0)
    v_readfirstlane_b32 s8, v14
    s_nop 0
    s_cmp_ge_u32 s8, 4
    s_cbranch_scc0 L_G_kw
    s_cmp_eq_u32 s13, 7
    s_cbranch_scc1 L_G3_now1
    buffer_load_ushort v20, v11, s[60:63], s12 offen offset:0
    buffer_load_ushort v24, v11, s[60:63], s12 offen offset:64
    s_add_u32 m0, s14, 0
    s_add_u32 s78, s76, 57344
    buffer_load_dwordx4 v4, s[56:59], s76 offen lds
    buffer_load_dwordx4 v5, s[56:59], s76 offen offset:1024 lds
    s_cmp_eq_u32 s78, s77
    s_cselect_b32 s76, s12, s78
    s_add_u32 m0, s14, 2048
    s_add_u32 s78, s76, 57344
    buffer_load_dwordx4 v4, s[56:59], s76 offen lds
    buffer_load_dwordx4 v5, s[56:59], s76 offen offset:1024 lds
    s_cmp_eq_u32 s78, s77
    s_cselect_b32 s76, s12, s78
    s_add_u32 m0, s14, 4096
    s_add_u32 s78, s76, 57344
    buffer_load_dwordx4 v4, s[56:59], s76 offen lds
    buffer_load_dwordx4 v5, s[56:59], s76 offen offset:1024 lds
    s_cmp_eq_u32 s78, s77
    s_cselect_b32 s76, s12, s78
    s_add_u32 m0, s14, 6144
    s_add_u32 s78, s76, 57344
    buffer_load_dwordx4 v4, s[56:59], s76 offen lds
    buffer_load_dwordx4 v5, s[56:59], s76 offen offset:1024 lds
    s_cmp_eq_u32 s78, s77
    s_cselect_b32 s76, s12, s78
L_G3_now1:
    s_waitcnt vmcnt(8)
    v_mfma_f32_32x32x16_bf16 v[64:79], v[20:23], v[28:31], 0
    v_mfma_f32_32x32x16_bf16 v[80:95], v[20:23], v[28:31], 0
    v_mfma_f32_32x32x16_bf16 v[96:111], v[24:27], v[28:31], 0
    v_mfma_f32_32x32x16_bf16 v[112:127], v[24:27], v[28:31], 0
    s_setprio 0
    s_waitcnt vmcnt(6)
    ds_read_b64_tr_b16 v[32:33], v224 offset:0
    ds_read_b64_tr_b16 v[34:35], v224 offset:512
    ds_read_b64_tr_b16 v[36:37], v225 offset:0
    ds_read_b64_tr_b16 v[38:39], v225 offset:512
    ds_read_b128 v[48:51], v16 offset:0
    ds_read_b128 v[52:55], v16 offset:4096
    s_waitcnt lgkmcnt(0)
    v_mfma_f32_32x32x16_bf16 v[64:79], v[32:35], v[48:51], v[64:79]
    s_waitcnt vmcnt(4)
    ds_read_b64_tr_b16 v[40:41], v224 offset:2048
    ds_read_b64_tr_b16 v[42:43], v224 offset:2560
    v_mfma_f32_32x32x16_bf16 v[80:95], v[32:35], v[52:55], v[80:95]
    ds_read_b128 v[56:59], v17 offset:0
    ds_read_b128 v[60:63], v17 offset:4096
    v_mfma_f32_32x32x16_bf16 v[96:111], v[36:39], v[48:51], v[96:111]
    ds_read_b64_tr_b16 v[44:45], v225 offset:2048
    ds_read_b64_tr_b16 v[46:47], v225 offset:2560
    v_mfma_f32_32x32x16_bf16 v[112:127], v[36:39], v[52:55], v[112:127]
    s_add_u32 m0, s14, 8192
    s_add_u32 s78, s76, 57344
    buffer_load_dwordx4 v4, s[56:59], s76 offen lds
    buffer_load_dwordx4 v5, s[56:59], s76 offen offset:1024 lds
    s_cmp_eq_u32 s78, s77
    s_cselect_b32 s76, s12, s78
    s_waitcnt lgkmcnt(0)
    v_mfma_f32_32x32x16_bf16 v[64:79], v[40:43], v[56:59], v[64:79]
    s_waitcnt vmcnt(4)
    ds_read_b64_tr_b16 v[32:33], v224 offset:4096
    ds_read_b64_tr_b16 v[34:35], v224 offset:4608
    v_mfma_f32_32x32x16_bf16 v[80:95], v[40:43], v[60:63], v[80:95]
    ds_read_b128 v[48:51], v18 offset:0
    ds_read_b128 v[52:55], v18 offset:4096
    v_mfma_f32_32x32x16_bf16 v[96:111], v[44:47], v[56:59], v[96:111]
    ds_read_b64_tr_b16 v[36:37], v225 offset:4096
    ds_read_b64_tr_b16 v[38:39], v225 offset:4608
    v_mfma_f32_32x32x16_bf16 v[112:127], v[44:47], v[60:63], v[112:127]
    s_add_u32 m0, s14, 10240
    s_add_u32 s78, s76, 57344
    buffer_load_dwordx4 v4, s[56:59], s76 offen lds
    buffer_load_dwordx4 v5, s[56:59], s76 offen offset:1024 lds
    s_cmp_eq_u32 s78, s77
    s_cselect_b32 s76, s12, s78
    s_waitcnt lgkmcnt(0)
    v_mfma_f32_32x32x16_bf16 v[64:79], v[32:35], v[48:51], v[64:79]
    s_waitcnt vmcnt(4)
    ds_read_b64_tr_b16 v[40:41], v224 offset:6144
    ds_read_b64_tr_b16 v[42:43], v224 offset:6656
    v_mfma_f32_32x32x16_bf16 v[80:95], v[32:35], v[52:55], v[80:95]
    ds_read_b128 v[56:59], v19 offset:0
    ds_read_b128 v[60:63], v19 offset:4096
    v_mfma_f32_32x32x16_bf16 v[96:111], v[36:39], v[48:51], v[96:111]
    ds_read_b64_tr_b16 v[44:45], v225 offset:6144
    ds_read_b64_tr_b16 v[46:47], v225 offset:6656
    v_mfma_f32_32x32x16_bf16 v[112:127], v[36:39], v[52:55], v[112:127]
    s_add_u32 m0, s14, 12288
    s_add_u32 s78, s76, 57344
    buffer_load_dwordx4 v4, s[56:59], s76 offen lds
    buffer_load_dwordx4 v5, s[56:59], s76 offen offset:1024 lds
    s_cmp_eq_u32 s78, s77
    s_cselect_b32 s76, s12, s78
    s_waitcnt lgkmcnt(0)
    v_mfma_f32_32x32x16_bf16 v[64:79], v[40:43], v[56:59], v[64:79]
    s_waitcnt vmcnt(4)
    ds_read_b64_tr_b16 v[32:33], v224 offset:8192
    ds_read_b64_tr_b16 v[34:35], v224 offset:8704
    v_mfma_f32_32x32x16_bf16 v[80:95], v[40:43], v[60:63], v[80:95]
    ds_read_b128 v[48:51], v16 offset:8192
    ds_read_b128 v[52:55], v16 offset:12288
    v_mfma_f32_32x32x16_bf16 v[96:111], v[44:47], v[56:59], v[96:111]
    ds_read_b64_tr_b16 v[36:37], v225 offset:8192
    ds_read_b64_tr_b16 v[38:39], v225 offset:8704
    v_mfma_f32_32x32x16_bf16 v[112:127], v[44:47], v[60:63], v[112:127]
    s_add_u32 m0, s14, 14336
    s_add_u32 s78, s76, 57344
    buffer_load_dwordx4 v4, s[56:59], s76 offen lds
    buffer_load_dwordx4 v5, s[56:59], s76 offen offset:1024 lds
    s_cmp_eq_u32 s78, s77
    s_cselect_b32 s76, s12, s78
    s_waitcnt lgkmcnt(0)
    v_mfma_f32_32x32x16_bf16 v[64:79], v[32:35], v[48:51], v[64:79]
    s_waitcnt vmcnt(4)
    ds_read_b64_tr_b16 v[40:41], v224 offset:10240
    ds_read_b64_tr_b16 v[42:43], v224 offset:10752
    v_mfma_f32_32x32x16_bf16 v[80:95], v[32:35], v[52:55], v[80:95]
    ds_read_b128 v[56:59], v17 offset:8192
    ds_read_b128 v[60:63], v17 offset:12288
    v_mfma_f32_32x32x16_bf16 v[96:111], v[36:39], v[48:51], v[96:111]
    ds_read_b64_tr_b16 v[44:45], v225 offset:10240
    ds_read_b64_tr_b16 v[46:47], v225 offset:10752
    v_mfma_f32_32x32x16_bf16 v[112:127], v[36:39], v[52:55], v[112:127]
    s_add_u32 m0, s14, 0
    s_add_u32 s78, s76, 57344
    buffer_load_dwordx4 v4, s[56:59], s76 offen lds
    buffer_load_dwordx4 v5, s[56:59], s76 offen offset:1024 lds
    s_cmp_eq_u32 s78, s77
    s_cselect_b32 s76, s12, s78
    s_waitcnt lgkmcnt(0)
    v_mfma_f32_32x32x16_bf16 v[64:79], v[40:43], v[56:59], v[64:79]
    s_waitcnt vmcnt(4)
    ds_read_b64_tr_b16 v[32:33], v224 offset:12288
    ds_read_b64_tr_b16 v[34:35], v224 offset:12800
    v_mfma_f32_32x32x16_bf16 v[80:95], v[40:43], v[60:63], v[80:95]
    ds_read_b128 v[48:51], v18 offset:8192
    ds_read_b128 v[52:55], v18 offset:12288
    v_mfma_f32_32x32x16_bf16 v[96:111], v[44:47], v[56:59], v[96:111]
    ds_read_b64_tr_b16 v[36:37], v225 offset:12288
    ds_read_b64_tr_b16 v[38:39], v225 offset:12800
    v_mfma_f32_32x32x16_bf16 v[112:127], v[44:47], v[60:63], v[112:127]
    s_add_u32 m0, s14, 2048
    s_add_u32 s78, s76, 57344
    buffer_load_dwordx4 v4, s[56:59], s76 offen lds
    buffer_load_dwordx4 v5, s[56:59], s76 offen offset:1024 lds
    s_cmp_eq_u32 s78, s77
    s_cselect_b32 s76, s12, s78
    s_waitcnt lgkmcnt(0)
    v_mfma_f32_32x32x16_bf16 v[64:79], v[32:35], v[48:51], v[64:79]
    s_waitcnt vmcnt(4)
    ds_read_b64_tr_b16 v[40:41], v224 offset:14336
    ds_read_b64_tr_b16 v[42:43], v224 offset:14848
    v_mfma_f32_32x32x16_bf16 v[80:95], v[32:35], v[52:55], v[80:95]
    ds_read_b128 v[56:59], v19 offset:8192
    ds_read_b128 v[60:63], v19 offset:12288
    v_mfma_f32_32x32x16_bf16 v[96:111], v[36:39], v[48:51], v[96:111]
    ds_read_b64_tr_b16 v[44:45], v225 offset:14336
    ds_read_b64_tr_b16 v[46:47], v225 offset:14848
    v_mfma_f32_32x32x16_bf16 v[112:127], v[36:39], v[52:55], v[112:127]
    s_add_u32 m0, s14, 4096
    s_add_u32 s78, s76, 57344
    buffer_load_dwordx4 v4, s[56:59], s76 offen lds
    buffer_load_dwordx4 v5, s[56:59], s76 offen offset:1024 lds
    s_cmp_eq_u32 s78, s77
    s_cselect_b32 s76, s12, s78
    s_waitcnt lgkmcnt(0)
    v_mfma_f32_32x32x16_bf16 v[64:79], v[40:43], v[56:59], v[64:79]
    s_waitcnt vmcnt(4)
    ds_read_b64_tr_b16 v[32:33], v224 offset:0
    ds_read_b64_tr_b16 v[34:35], v224 offset:512
    v_mfma_f32_32x32x16_bf16 v[80:95], v[40:43], v[60:63], v[80:95]
    ds_read_b128 v[48:51], v16 offset:16384
    ds_read_b128 v[52:55], v16 offset:20480
    v_mfma_f32_32x32x16_bf16 v[96:111], v[44:47], v[56:59], v[96:111]
    ds_read_b64_tr_b16 v[36:37], v225 offset:0
    ds_read_b64_tr_b16 v[38:39], v225 offset:512
    v_mfma_f32_32x32x16_bf16 v[112:127], v[44:47], v[60:63], v[112:127]
    s_add_u32 m0, s14, 6144
    s_add_u32 s78, s76, 57344
    buffer_load_dwordx4 v4, s[56:59], s76 offen lds
    buffer_load_dwordx4 v5, s[56:59], s76 offen offset:1024 lds
    s_cmp_eq_u32 s78, s77
    s_cselect_b32 s76, s12, s78
    s_waitcnt lgkmcnt(0)
    v_mfma_f32_32x32x16_bf16 v[64:79], v[32:35], v[48:51], v[64:79]
    s_waitcnt vmcnt(4)
    ds_read_b64_tr_b16 v[40:41], v224 offset:2048
    ds_read_b64_tr_b16 v[42:43], v224 offset:2560
    v_mfma_f32_32x32x16_bf16 v[80:95], v[32:35], v[52:55], v[80:95]
    ds_read_b128 v[56:59], v17 offset:16384
    ds_read_b128 v[60:63], v17 offset:20480
    v_mfma_f32_32x32x16_bf16 v[96:111], v[36:39], v[48:51], v[96:111]
    ds_read_b64_tr_b16 v[44:45], v225 offset:2048
    ds_read_b64_tr_b16 v[46:47], v225 offset:2560
    v_mfma_f32_32x32x16_bf16 v[112:127], v[36:39], v[52:55], v[112:127]
    s_add_u32 m0, s14, 8192
    s_add_u32 s78, s76, 57344
    buffer_load_dwordx4 v4, s[56:59], s76 offen lds
    buffer_load_dwordx4 v5, s[56:59], s76 offen offset:1024 lds
    s_cmp_eq_u32 s78, s77
    s_cselect_b32 s76, s12, s78
    s_waitcnt lgkmcnt(0)
    v_mfma_f32_32x32x16_bf16 v[64:79], v[40:43], v[56:59], v[64:79]
    s_waitcnt vmcnt(4)
    ds_read_b64_tr_b16 v[32:33], v224 offset:4096
    ds_read_b64_tr_b16 v[34:35], v224 offset:4608
    v_mfma_f32_32x32x16_bf16 v[80:95], v[40:43], v[60:63], v[80:95]
    ds_read_b128 v[48:51], v18 offset:16384
    ds_read_b128 v[52:55], v18 offset:20480
    v_mfma_f32_32x32x16_bf16 v[96:111], v[44:47], v[56:59], v[96:111]
    ds_read_b64_tr_b16 v[36:37], v225 offset:4096
    ds_read_b64_tr_b16 v[38:39], v225 offset:4608
    v_mfma_f32_32x32x16_bf16 v[112:127], v[44:47], v[60:63], v[112:127]
    s_add_u32 m0, s14, 10240
    s_add_u32 s78, s76, 57344
    buffer_load_dwordx4 v4, s[56:59], s76 offen lds
    buffer_load_dwordx4 v5, s[56:59], s76 offen offset:1024 lds
    s_cmp_eq_u32 s78, s77
    s_cselect_b32 s76, s12, s78
    s_waitcnt lgkmcnt(0)
    v_mfma_f32_32x32x16_bf16 v[64:79], v[32:35], v[48:51], v[64:79]
    s_waitcnt vmcnt(4)
    ds_read_b64_tr_b16 v[40:41], v224 offset:6144
    ds_read_b64_tr_b16 v[42:43], v224 offset:6656
    v_mfma_f32_32x32x16_bf16 v[80:95], v[32:35], v[52:55], v[80:95]
    ds_read_b128 v[56:59], v19 offset:16384
    ds_read_b128 v[60:63], v19 offset:20480
    v_mfma_f32_32x32x16_bf16 v[96:111], v[36:39], v[48:51], v[96:111]
    ds_read_b64_tr_b16 v[44:45], v225 offset:6144
    ds_read_b64_tr_b16 v[46:47], v225 offset:6656
    v_mfma_f32_32x32x16_bf16 v[112:127], v[36:39], v[52:55], v[112:127]
    s_add_u32 m0, s14, 12288
    s_add_u32 s78, s76, 57344
    buffer_load_dwordx4 v4, s[56:59], s76 offen lds
    buffer_load_dwordx4 v5, s[56:59], s76 offen offset:1024 lds
    s_cmp_eq_u32 s78, s77
    s_cselect_b32 s76, s12, s78
    s_waitcnt lgkmcnt(0)
    v_mfma_f32_32x32x16_bf16 v[64:79], v[40:43], v[56:59], v[64:79]
    s_waitcnt vmcnt(4)
    ds_read_b64_tr_b16 v[32:33], v224 offset:8192
    ds_read_b64_tr_b16 v[34:35], v224 offset:8704
    v_mfma_f32_32x32x16_bf16 v[80:95], v[40:43], v[60:63], v[80:95]
    ds_read_b128 v[48:51], v16 offset:24576
    ds_read_b128 v[52:55], v16 offset:28672
    v_mfma_f32_32x32x16_bf16 v[96:111], v[44:47], v[56:59], v[96:111]
    ds_read_b64_tr_b16 v[36:37], v225 offset:8192
    ds_read_b64_tr_b16 v[38:39], v225 offset:8704
    v_mfma_f32_32x32x16_bf16 v[112:127], v[44:47], v[60:63], v[112:127]
    s_add_u32 m0, s14, 14336
    s_add_u32 s78, s76, 57344
    buffer_load_dwordx4 v4, s[56:59], s76 offen lds
    buffer_load_dwordx4 v5, s[56:59], s76 offen offset:1024 lds
    s_cmp_eq_u32 s78, s77
    s_cselect_b32 s76, s12, s78
    s_waitcnt lgkmcnt(0)
    v_mfma_f32_32x32x16_bf16 v[64:79], v[32:35], v[48:51], v[64:79]
    s_waitcnt vmcnt(4)
    ds_read_b64_tr_b16 v[40:41], v224 offset:10240
    ds_read_b64_tr_b16 v[42:43], v224 offset:10752
    v_mfma_f32_32x32x16_bf16 v[80:95], v[32:35], v[52:55], v[80:95]
    ds_read_b128 v[56:59], v17 offset:24576
    ds_read_b128 v[60:63], v17 offset:28672
    v_mfma_f32_32x32x16_bf16 v[96:111], v[36:39], v[48:51], v[96:111]
    ds_read_b64_tr_b16 v[44:45], v225 offset:10240
    ds_read_b64_tr_b16 v[46:47], v225 offset:10752
    v_mfma_f32_32x32x16_bf16 v[112:127], v[36:39], v[52:55], v[112:127]
    s_add_u32 m0, s14, 0
    s_add_u32 s78, s76, 57344
    buffer_load_dwordx4 v4, s[56:59], s76 offen lds
    buffer_load_dwordx4 v5, s[56:59], s76 offen offset:1024 lds
    s_cmp_eq_u32 s78, s77
    s_cselect_b32 s76, s12, s78
    s_waitcnt lgkmcnt(0)
    v_mfma_f32_32x32x16_bf16 v[64:79], v[40:43], v[56:59], v[64:79]
    s_waitcnt vmcnt(4)
    ds_read_b64_tr_b16 v[32:33], v224 offset:12288
    ds_read_b64_tr_b16 v[34:35], v224 offset:12800
    v_mfma_f32_32x32x16_bf16 v[80:95], v[40:43], v[60:63], v[80:95]
    ds_read_b128 v[48:51], v18 offset:24576
    ds_read_b128 v[52:55], v18 offset:28672
    v_mfma_f32_32x32x16_bf16 v[96:111], v[44:47], v[56:59], v[96:111]
    ds_read_b64_tr_b16 v[36:37], v225 offset:12288
    ds_read_b64_tr_b16 v[38:39], v225 offset:12800
    v_mfma_f32_32x32x16_bf16 v[112:127], v[44:47], v[60:63], v[112:127]
    s_add_u32 m0, s14, 2048
    s_add_u32 s78, s76, 57344
    buffer_load_dwordx4 v4, s[56:59], s76 offen lds
    buffer_load_dwordx4 v5, s[56:59], s76 offen offset:1024 lds
    s_cmp_eq_u32 s78, s77
    s_cselect_b32 s76, s12, s78
    s_waitcnt lgkmcnt(0)
    v_mfma_f32_32x32x16_bf16 v[64:79], v[32:35], v[48:51], v[64:79]
    s_waitcnt vmcnt(4)
    ds_read_b64_tr_b16 v[40:41], v224 offset:14336
    ds_read_b64_tr_b16 v[42:43], v224 offset:14848
    v_mfma_f32_32x32x16_bf16 v[80:95], v[32:35], v[52:55], v[80:95]
    ds_read_b128 v[56:59], v19 offset:24576
    ds_read_b128 v[60:63], v19 offset:28672
    v_mfma_f32_32x32x16_bf16 v[96:111], v[36:39], v[48:51], v[96:111]
    ds_read_b64_tr_b16 v[44:45], v225 offset:14336
    ds_read_b64_tr_b16 v[46:47], v225 offset:14848
    v_mfma_f32_32x32x16_bf16 v[112:127], v[36:39], v[52:55], v[112:127]
    s_add_u32 m0, s14, 4096
    s_add_u32 s78, s76, 57344
    buffer_load_dwordx4 v4, s[56:59], s76 offen lds
    buffer_load_dwordx4 v5, s[56:59], s76 offen offset:1024 lds
    s_cmp_eq_u32 s78, s77
    s_cselect_b32 s76, s12, s78
    s_waitcnt lgkmcnt(0)
    v_mfma_f32_32x32x16_bf16 v[64:79], v[40:43], v[56:59], v[64:79]
    s_waitcnt vmcnt(4)
    ds_read_b64_tr_b16 v[32:33], v224 offset:0
    ds_read_b64_tr_b16 v[34:35], v224 offset:512
    v_mfma_f32_32x32x16_bf16 v[80:95], v[40:43], v[60:63], v[80:95]
    ds_read_b128 v[48:51], v16 offset:32768
    ds_read_b128 v[52:55], v16 offset:36864
    v_mfma_f32_32x32x16_bf16 v[96:111], v[44:47], v[56:59], v[96:111]
    ds_read_b64_tr_b16 v[36:37], v225 offset:0
    ds_read_b64_tr_b16 v[38:39], v225 offset:512
    v_mfma_f32_32x32x16_bf16 v[112:127], v[44:47], v[60:63], v[112:127]
    s_add_u32 m0, s14, 6144
    s_add_u32 s78, s76, 57344
    buffer_load_dwordx4 v4, s[56:59], s76 offen lds
    buffer_load_dwordx4 v5, s[56:59], s76 offen offset:1024 lds
    s_cmp_eq_u32 s78, s77
    s_cselect_b32 s76, s12, s78
    s_waitcnt lgkmcnt(0)
    v_mfma_f32_32x32x16_bf16 v[64:79], v[32:35], v[48:51], v[64:79]
    s_waitcnt vmcnt(4)
    ds_read_b64_tr_b16 v[40:41], v224 offset:2048
    ds_read_b64_tr_b16 v[42:43], v224 offset:2560
    v_mfma_f32_32x32x16_bf16 v[80:95], v[32:35], v[52:55], v[80:95]
    ds_read_b128 v[56:59], v17 offset:32768
    ds_read_b128 v[60:63], v17 offset:36864
    v_mfma_f32_32x32x16_bf16 v[96:111], v[36:39], v[48:51], v[96:111]
    ds_read_b64_tr_b16 v[44:45], v225 offset:2048
    ds_read_b64_tr_b16 v[46:47], v225 offset:2560
    v_mfma_f32_32x32x16_bf16 v[112:127], v[36:39], v[52:55], v[112:127]
    s_add_u32 m0, s14, 8192
    s_add_u32 s78, s76, 57344
    buffer_load_dwordx4 v4, s[56:59], s76 offen lds
    buffer_load_dwordx4 v5, s[56:59], s76 offen offset:1024 lds
    s_cmp_eq_u32 s78, s77
    s_cselect_b32 s76, s12, s78
    s_waitcnt lgkmcnt(0)
    v_mfma_f32_32x32x16_bf16 v[64:79], v[40:43], v[56:59], v[64:79]
    s_waitcnt vmcnt(4)
    ds_read_b64_tr_b16 v[32:33], v224 offset:4096
    ds_read_b64_tr_b16 v[34:35], v224 offset:4608
    v_mfma_f32_32x32x16_bf16 v[80:95], v[40:43], v[60:63], v[80:95]
    ds_read_b128 v[48:51], v18 offset:32768
    ds_read_b128 v[52:55], v18 offset:36864
    v_mfma_f32_32x32x16_bf16 v[96:111], v[44:47], v[56:59], v[96:111]
    ds_read_b64_tr_b16 v[36:37], v225 offset:4096
    ds_read_b64_tr_b16 v[38:39], v225 offset:4608
    v_mfma_f32_32x32x16_bf16 v[112:127], v[44:47], v[60:63], v[112:127]
    s_add_u32 m0, s14, 10240
    s_add_u32 s78, s76, 57344
    buffer_load_dwordx4 v4, s[56:59], s76 offen lds
    buffer_load_dwordx4 v5, s[56:59], s76 offen offset:1024 lds
    s_cmp_eq_u32 s78, s77
    s_cselect_b32 s76, s12, s78
    s_waitcnt lgkmcnt(0)
    v_mfma_f32_32x32x16_bf16 v[64:79], v[32:35], v[48:51], v[64:79]
    s_waitcnt vmcnt(4)
    ds_read_b64_tr_b16 v[40:41], v224 offset:6144
    ds_read_b64_tr_b16 v[42:43], v224 offset:6656
    v_mfma_f32_32x32x16_bf16 v[80:95], v[32:35], v[52:55], v[80:95]
    ds_read_b128 v[56:59], v19 offset:32768
    ds_read_b128 v[60:63], v19 offset:36864
    v_mfma_f32_32x32x16_bf16 v[96:111], v[36:39], v[48:51], v[96:111]
    ds_read_b64_tr_b16 v[44:45], v225 offset:6144
    ds_read_b64_tr_b16 v[46:47], v225 offset:6656
    v_mfma_f32_32x32x16_bf16 v[112:127], v[36:39], v[52:55], v[112:127]
    s_add_u32 m0, s14, 12288
    s_add_u32 s78, s76, 57344
    buffer_load_dwordx4 v4, s[56:59], s76 offen lds
    buffer_load_dwordx4 v5, s[56:59], s76 offen offset:1024 lds
    s_cmp_eq_u32 s78, s77
    s_cselect_b32 s76, s12, s78
    s_waitcnt lgkmcnt(0)
    v_mfma_f32_32x32x16_bf16 v[64:79], v[40:43], v[56:59], v[64:79]
    s_waitcnt vmcnt(4)
    ds_read_b64_tr_b16 v[32:33], v224 offset:8192
    ds_read_b64_tr_b16 v[34:35], v224 offset:8704
    v_mfma_f32_32x32x16_bf16 v[80:95], v[40:43], v[60:63], v[80:95]
    ds_read_b128 v[48:51], v16 offset:40960
    ds_read_b128 v[52:55], v16 offset:45056
    v_mfma_f32_32x32x16_bf16 v[96:111], v[44:47], v[56:59], v[96:111]
    ds_read_b64_tr_b16 v[36:37], v225 offset:8192
    ds_read_b64_tr_b16 v[38:39], v225 offset:8704
    v_mfma_f32_32x32x16_bf16 v[112:127], v[44:47], v[60:63], v[112:127]
    s_add_u32 m0, s14, 14336
    s_add_u32 s78, s76, 57344
    buffer_load_dwordx4 v4, s[56:59], s76 offen lds
    buffer_load_dwordx4 v5, s[56:59], s76 offen offset:1024 lds
    s_cmp_eq_u32 s78, s77
    s_cselect_b32 s76, s12, s78
    s_waitcnt lgkmcnt(0)
    v_mfma_f32_32x32x16_bf16 v[64:79], v[32:35], v[48:51], v[64:79]
    s_waitcnt vmcnt(4)
    ds_read_b64_tr_b16 v[40:41], v224 offset:10240
    ds_read_b64_tr_b16 v[42:43], v224 offset:10752
    v_mfma_f32_32x32x16_bf16 v[80:95], v[32:35], v[52:55], v[80:95]
    ds_read_b128 v[56:59], v17 offset:40960
    ds_read_b128 v[60:63], v17 offset:45056
    v_mfma_f32_32x32x16_bf16 v[96:111], v[36:39], v[48:51], v[96:111]
    ds_read_b64_tr_b16 v[44:45], v225 offset:10240
    ds_read_b64_tr_b16 v[46:47], v225 offset:10752
    v_mfma_f32_32x32x16_bf16 v[112:127], v[36:39], v[52:55], v[112:127]
    s_add_u32 m0, s14, 0
    s_add_u32 s78, s76, 57344
    buffer_load_dwordx4 v4, s[56:59], s76 offen lds
    buffer_load_dwordx4 v5, s[56:59], s76 offen offset:1024 lds
    s_cmp_eq_u32 s78, s77
    s_cselect_b32 s76, s12, s78
    s_waitcnt lgkmcnt(0)
    v_mfma_f32_32x32x16_bf16 v[64:79], v[40:43], v[56:59], v[64:79]
    s_waitcnt vmcnt(4)
    ds_read_b64_tr_b16 v[32:33], v224 offset:12288
    ds_read_b64_tr_b16 v[34:35], v224 offset:12800
    v_mfma_f32_32x32x16_bf16 v[80:95], v[40:43], v[60:63], v[80:95]
    ds_read_b128 v[48:51], v18 offset:40960
    ds_read_b128 v[52:55], v18 offset:45056
    v_mfma_f32_32x32x16_bf16 v[96:111], v[44:47], v[56:59], v[96:111]
    ds_read_b64_tr_b16 v[36:37], v225 offset:12288
    ds_read_b64_tr_b16 v[38:39], v225 offset:12800
    v_mfma_f32_32x32x16_bf16 v[112:127], v[44:47], v[60:63], v[112:127]
    s_add_u32 m0, s14, 2048
    s_add_u32 s78, s76, 57344
    buffer_load_dwordx4 v4, s[56:59], s76 offen lds
    buffer_load_dwordx4 v5, s[56:59], s76 offen offset:1024 lds
    s_cmp_eq_u32 s78, s77
    s_cselect_b32 s76, s12, s78
    s_waitcnt lgkmcnt(0)
    v_mfma_f32_32x32x16_bf16 v[64:79], v[32:35], v[48:51], v[64:79]
    s_waitcnt vmcnt(4)
    ds_read_b64_tr_b16 v[40:41], v224 offset:14336
    ds_read_b64_tr_b16 v[42:43], v224 offset:14848
    v_mfma_f32_32x32x16_bf16 v[80:95], v[32:35], v[52:55], v[80:95]
    ds_read_b128 v[56:59], v19 offset:40960
    ds_read_b128 v[60:63], v19 offset:45056
    v_mfma_f32_32x32x16_bf16 v[96:111], v[36:39], v[48:51], v[96:111]
    ds_read_b64_tr_b16 v[44:45], v225 offset:14336
    ds_read_b64_tr_b16 v[46:47], v225 offset:14848
    v_mfma_f32_32x32x16_bf16 v[112:127], v[36:39], v[52:55], v[112:127]
    s_add_u32 m0, s14, 4096
    s_add_u32 s78, s76, 57344
    buffer_load_dwordx4 v4, s[56:59], s76 offen lds
    buffer_load_dwordx4 v5, s[56:59], s76 offen offset:1024 lds
    s_cmp_eq_u32 s78, s77
    s_cselect_b32 s76, s12, s78
    s_waitcnt lgkmcnt(0)
    v_mfma_f32_32x32x16_bf16 v[64:79], v[40:43], v[56:59], v[64:79]
    s_waitcnt vmcnt(4)
    ds_read_b64_tr_b16 v[32:33], v224 offset:0
    ds_read_b64_tr_b16 v[34:35], v224 offset:512
    v_mfma_f32_32x32x16_bf16 v[80:95], v[40:43], v[60:63], v[80:95]
    ds_read_b128 v[48:51], v16 offset:49152
    ds_read_b128 v[52:55], v16 offset:53248
    v_mfma_f32_32x32x16_bf16 v[96:111], v[44:47], v[56:59], v[96:111]
    ds_read_b64_tr_b16 v[36:37], v225 offset:0
    ds_read_b64_tr_b16 v[38:39], v225 offset:512
    v_mfma_f32_32x32x16_bf16 v[112:127], v[44:47], v[60:63], v[112:127]
    s_add_u32 m0, s14, 6144
    s_add_u32 s78, s76, 57344
    buffer_load_dwordx4 v4, s[56:59], s76 offen lds
    buffer_load_dwordx4 v5, s[56:59], s76 offen offset:1024 lds
    s_cmp_eq_u32 s78, s77
    s_cselect_b32 s76, s12, s78
    s_waitcnt lgkmcnt(0)
    v_mfma_f32_32x32x16_bf16 v[64:79], v[32:35], v[48:51], v[64:79]
    s_waitcnt vmcnt(4)
    ds_read_b64_tr_b16 v[40:41], v224 offset:2048
    ds_read_b64_tr_b16 v[42:43], v224 offset:2560
    v_mfma_f32_32x32x16_bf16 v[80:95], v[32:35], v[52:55], v[80:95]
    ds_read_b128 v[56:59], v17 offset:49152
    ds_read_b128 v[60:63], v17 offset:53248
    v_mfma_f32_32x32x16_bf16 v[96:111], v[36:39], v[48:51], v[96:111]
    ds_read_b64_tr_b16 v[44:45], v225 offset:2048
    ds_read_b64_tr_b16 v[46:47], v225 offset:2560
    v_mfma_f32_32x32x16_bf16 v[112:127], v[36:39], v[52:55], v[112:127]
    s_add_u32 m0, s14, 8192
    s_add_u32 s78, s76, 57344
    buffer_load_dwordx4 v4, s[56:59], s76 offen lds
    buffer_load_dwordx4 v5, s[56:59], s76 offen offset:1024 lds
    s_cmp_eq_u32 s78, s77
    s_cselect_b32 s76, s12, s78
    s_waitcnt lgkmcnt(0)
    v_mfma_f32_32x32x16_bf16 v[64:79], v[40:43], v[56:59], v[64:79]
    s_waitcnt vmcnt(4)
    ds_read_b64_tr_b16 v[32:33], v224 offset:4096
    ds_read_b64_tr_b16 v[34:35], v224 offset:4608
    v_mfma_f32_32x32x16_bf16 v[80:95], v[40:43], v[60:63], v[80:95]
    ds_read_b128 v[48:51], v18 offset:49152
    ds_read_b128 v[52:55], v18 offset:53248
    v_mfma_f32_32x32x16_bf16 v[96:111], v[44:47], v[56:59], v[96:111]
    ds_read_b64_tr_b16 v[36:37], v225 offset:4096
    ds_read_b64_tr_b16 v[38:39], v225 offset:4608
    v_mfma_f32_32x32x16_bf16 v[112:127], v[44:47], v[60:63], v[112:127]
    s_add_u32 m0, s14, 10240
    s_add_u32 s78, s76, 57344
    buffer_load_dwordx4 v4, s[56:59], s76 offen lds
    buffer_load_dwordx4 v5, s[56:59], s76 offen offset:1024 lds
    s_cmp_eq_u32 s78, s77
    s_cselect_b32 s76, s12, s78
    s_waitcnt lgkmcnt(0)
    v_mfma_f32_32x32x16_bf16 v[64:79], v[32:35], v[48:51], v[64:79]
    s_waitcnt vmcnt(4)
    ds_read_b64_tr_b16 v[40:41], v224 offset:6144
    ds_read_b64_tr_b16 v[42:43], v224 offset:6656
    v_mfma_f32_32x32x16_bf16 v[80:95], v[32:35], v[52:55], v[80:95]
    ds_read_b128 v[56:59], v19 offset:49152
    ds_read_b128 v[60:63], v19 offset:53248
    v_mfma_f32_32x32x16_bf16 v[96:111], v[36:39], v[48:51], v[96:111]
    ds_read_b64_tr_b16 v[44:45], v225 offset:6144
    ds_read_b64_tr_b16 v[46:47], v225 offset:6656
    v_mfma_f32_32x32x16_bf16 v[112:127], v[36:39], v[52:55], v[112:127]
    s_add_u32 m0, s14, 12288
    s_add_u32 s78, s76, 57344
    buffer_load_dwordx4 v4, s[56:59], s76 offen lds
    buffer_load_dwordx4 v5, s[56:59], s76 offen offset:1024 lds
    s_cmp_eq_u32 s78, s77
    s_cselect_b32 s76, s12, s78
    s_waitcnt lgkmcnt(0)
    v_mfma_f32_32x32x16_bf16 v[64:79], v[40:43], v[56:59], v[64:79]
    s_waitcnt vmcnt(4)
    ds_read_b64_tr_b16 v[32:33], v224 offset:8192
    ds_read_b64_tr_b16 v[34:35], v224 offset:8704
    v_mfma_f32_32x32x16_bf16 v[80:95], v[40:43], v[60:63], v[80:95]
    ds_read_b128 v[48:51], v16 offset:57344
    ds_read_b128 v[52:55], v16 offset:61440
    v_mfma_f32_32x32x16_bf16 v[96:111], v[44:47], v[56:59], v[96:111]
    ds_read_b64_tr_b16 v[36:37], v225 offset:8192
    ds_read_b64_tr_b16 v[38:39], v225 offset:8704
    v_mfma_f32_32x32x16_bf16 v[112:127], v[44:47], v[60:63], v[112:127]
    s_add_u32 m0, s14, 14336
    s_add_u32 s78, s76, 57344
    buffer_load_dwordx4 v4, s[56:59], s76 offen lds
    buffer_load_dwordx4 v5, s[56:59], s76 offen offset:1024 lds
    s_cmp_eq_u32 s78, s77
    s_cselect_b32 s76, s12, s78
    s_waitcnt lgkmcnt(0)
    v_mfma_f32_32x32x16_bf16 v[64:79], v[32:35], v[48:51], v[64:79]
    s_waitcnt vmcnt(4)
    ds_read_b64_tr_b16 v[40:41], v224 offset:10240
    ds_read_b64_tr_b16 v[42:43], v224 offset:10752
    v_mfma_f32_32x32x16_bf16 v[80:95], v[32:35], v[52:55], v[80:95]
    ds_read_b128 v[56:59], v17 offset:57344
    ds_read_b128 v[60:63], v17 offset:61440
    v_mfma_f32_32x32x16_bf16 v[96:111], v[36:39], v[48:51], v[96:111]
    ds_read_b64_tr_b16 v[44:45], v225 offset:10240
    ds_read_b64_tr_b16 v[46:47], v225 offset:10752
    v_mfma_f32_32x32x16_bf16 v[112:127], v[36:39], v[52:55], v[112:127]
    s_waitcnt lgkmcnt(0)
    v_mfma_f32_32x32x16_bf16 v[64:79], v[40:43], v[56:59], v[64:79]
    s_waitcnt vmcnt(2)
    ds_read_b64_tr_b16 v[32:33], v224 offset:12288
    ds_read_b64_tr_b16 v[34:35], v224 offset:12800
    v_mfma_f32_32x32x16_bf16 v[80:95], v[40:43], v[60:63], v[80:95]
    ds_read_b128 v[48:51], v18 offset:57344
    ds_read_b128 v[52:55], v18 offset:61440
    v_mfma_f32_32x32x16_bf16 v[96:111], v[44:47], v[56:59], v[96:111]
    ds_read_b64_tr_b16 v[36:37], v225 offset:12288
    ds_read_b64_tr_b16 v[38:39], v225 offset:12800
    v_mfma_f32_32x32x16_bf16 v[112:127], v[44:47], v[60:63], v[112:127]
    s_waitcnt lgkmcnt(0)
    v_mfma_f32_32x32x16_bf16 v[64:79], v[32:35], v[48:51], v[64:79]
    s_waitcnt vmcnt(0)
    ds_read_b64_tr_b16 v[40:41], v224 offset:14336
    ds_read_b64_tr_b16 v[42:43], v224 offset:14848
    v_mfma_f32_32x32x16_bf16 v[80:95], v[32:35], v[52:55], v[80:95]
    ds_read_b128 v[56:59], v19 offset:57344
    ds_read_b128 v[60:63], v19 offset:61440
    v_mfma_f32_32x32x16_bf16 v[96:111], v[36:39], v[48:51], v[96:111]
    ds_read_b64_tr_b16 v[44:45], v225 offset:14336
    ds_read_b64_tr_b16 v[46:47], v225 offset:14848
    v_mfma_f32_32x32x16_bf16 v[112:127], v[36:39], v[52:55], v[112:127]
    s_waitcnt lgkmcnt(0)
    v_mfma_f32_32x32x16_bf16 v[64:79], v[40:43], v[56:59], v[64:79]
    v_mfma_f32_32x32x16_bf16 v[80:95], v[40:43], v[60:63], v[80:95]
    v_mfma_f32_32x32x16_bf16 v[96:111], v[44:47], v[56:59], v[96:111]
    v_mfma_f32_32x32x16_bf16 v[112:127], v[44:47], v[60:63], v[112:127]
    s_setprio 2
    s_mov_b64 exec, 1
    ds_add_u32 v12, v8 offset:20
    s_mov_b64 exec, -1
L_G_ffn1_end:
    ds_read_b32 v8, v12 offset:24
    s_waitcnt lgkmcnt(0)
    v_readfirstlane_b32 s59, v8
    s_mov_b32 s76, s32
    s_mov_b32 s77, s33
    s_mov_b32 s78, 0x1c0000
    s_mov_b32 s79, 0x20000
    s_mov_b32 s48, s34
    s_mov_b32 s49, s35
    s_mov_b32 s50, 0x400
    s_mov_b32 s51, 0x20000
    s_lshl_b32 s8, s5, 7
    s_cmp_eq_u32 s6, 0
    s_cselect_b32 s10, s8, 0x40000000
    buffer_load_ushort v20, v11, s[48:51], s10 offen offset:0
    buffer_load_ushort v24, v11, s[48:51], s10 offen offset:64
    s_lshl_b32 s10, s4, 5
    s_lshl_b32 s9, s5, 2
    s_add_u32 s10, s10, s9
    s_add_u32 s10, s10, s6
    s_lshl_b32 s10, s10, 11
    s_add_u32 s10, s10, 262144
    v_mov_b32 v48, -1
    v_mov_b32 v49, -1
    v_mov_b32 v50, -1
    v_mov_b32 v51, -1
    buffer_store_dwordx4 v[48:51], v2, s[68:71], s10 offen offset:0 sc1
    buffer_store_dwordx4 v[48:51], v2, s[68:71], s10 offen offset:1024 sc1
    s_mul_i32 s66, s6, 458752
    s_add_u32 s66, s66, s8
    s_mov_b32 s80, s24
    s_mov_b32 s81, s25
    s_mov_b32 s82, 0x80000
    s_mov_b32 s83, 0x20000
    s_lshl_b32 s8, s5, 7
    s_lshl_b32 s52, s6, 16
    s_add_u32 s52, s52, s8
    s_and_b32 s55, s15, 3
    s_lshl_b32 s67, s55, 15
    s_mul_i32 s60, s15, 7
    s_and_b32 s61, s5, 3
    s_mul_i32 s61, s61, 14
    s_add_u32 s60, s60, s61
    s_lshr_b32 s60, s60, 1
    s_sub_u32 s61, s60, 28
    s_cselect_b32 s60, s60, s61
    s_mov_b32 s61, s66
    s_add_u32 s62, s66, 458752
    s_lshl_b32 s63, s60, 14
    s_add_u32 s66, s66, s63
    v_mov_b32 v54, v226
    v_mov_b32 v55, v227
    s_mul_i32 s8, s4, 112
    s_lshl_b32 s10, s8, 11
    s_lshl_b32 s9, s12, 6
    s_add_u32 s10, s10, s9
    s_add_u32 s12, s10, 2359296
    s_cmp_eq_u32 s13, 7
    s_cselect_b32 s56, 1, 0
    s_add_u32 s13, s12, 4096
    s_mul_i32 s9, s6, 28
    s_add_u32 s9, s9, s8
    s_lshl_b32 s9, s9, 11
    s_add_u32 s64, s9, 2359296
    s_add_u32 s65, s64, 57344
    s_lshl_b32 s9, s60, 11
    s_add_u32 s9, s9, s64
    s_lshl_b32 s11, s4, 9
    s_add_u32 s11, s11, 163840
    s_and_b32 s10, s5, 3
    s_lshl_b32 s10, s10, 7
    s_add_u32 s10, s10, s11
    s_lshr_b32 s8, s5, 2
    s_lshl_b32 s8, s8, 2
    s_add_u32 s8, s8, s6
    s_lshl_b32 s8, s8, 2
    s_add_u32 s57, s10, s8
    s_lshl_b32 s8, s6, 7
    s_add_u32 s11, s11, s8
    v_and_b32 v14, 7, v0
    v_lshlrev_b32 v14, 2, v14
    s_cmp_eq_u32 s56, 1
    s_cbranch_scc1 L_G_noh
    v_max_f32 v64, 0, v64
    v_max_f32 v65, 0, v65
    v_max_f32 v66, 0, v66
    v_max_f32 v67, 0, v67
    v_max_f32 v68, 0, v68
    v_max_f32 v69, 0, v69
    v_max_f32 v70, 0, v70
    v_max_f32 v71, 0, v71
    v_max_f32 v72, 0, v72
    v_max_f32 v73, 0, v73
    v_max_f32 v74, 0, v74
    v_max_f32 v75, 0, v75
    v_max_f32 v76, 0, v76
    v_max_f32 v77, 0, v77
    v_max_f32 v78, 0, v78
    v_max_f32 v79, 0, v79
    v_pk_mul_f32 v[64:65], v[64:65], v[64:65]
    v_pk_mul_f32 v[66:67], v[66:67], v[66:67]
    v_pk_mul_f32 v[68:69], v[68:69], v[68:69]
    v_pk_mul_f32 v[70:71], v[70:71], v[70:71]
    v_pk_mul_f32 v[72:73], v[72:73], v[72:73]
    v_pk_mul_f32 v[74:75], v[74:75], v[74:75]
    v_pk_mul_f32 v[76:77], v[76:77], v[76:77]
    v_pk_mul_f32 v[78:79], v[78:79], v[78:79]
    v_cvt_pk_bf16_f32 v192, v64, v65
    v_cvt_pk_bf16_f32 v193, v66, v67
    v_cvt_pk_bf16_f32 v194, v68, v69
    v_cvt_pk_bf16_f32 v195, v70, v71
    v_cvt_pk_bf16_f32 v196, v72, v73
    v_cvt_pk_bf16_f32 v197, v74, v75
    v_cvt_pk_bf16_f32 v198, v76, v77
    v_cvt_pk_bf16_f32 v199, v78, v79
    buffer_store_dwordx4 v[192:195], v2, s[68:71], s12 offen offset:0 sc1
    buffer_store_dwordx4 v[196:199], v2, s[68:71], s12 offen offset:2048 sc1
    v_max_f32 v80, 0, v80
    v_max_f32 v81, 0, v81
    v_max_f32 v82, 0, v82
    v_max_f32 v83, 0, v83
    v_max_f32 v84, 0, v84
    v_max_f32 v85, 0, v85
    v_max_f32 v86, 0, v86
    v_max_f32 v87, 0, v87
    v_max_f32 v88, 0, v88
    v_max_f32 v89, 0, v89
    v_max_f32 v90, 0, v90
    v_max_f32 v91, 0, v91
    v_max_f32 v92, 0, v92
    v_max_f32 v93, 0, v93
    v_max_f32 v94, 0, v94
    v_max_f32 v95, 0, v95
    v_pk_mul_f32 v[80:81], v[80:81], v[80:81]
    v_pk_mul_f32 v[82:83], v[82:83], v[82:83]
    v_pk_mul_f32 v[84:85], v[84:85], v[84:85]
    v_pk_mul_f32 v[86:87], v[86:87], v[86:87]
    v_pk_mul_f32 v[88:89], v[88:89], v[88:89]
    v_pk_mul_f32 v[90:91], v[90:91], v[90:91]
    v_pk_mul_f32 v[92:93], v[92:93], v[92:93]
    v_pk_mul_f32 v[94:95], v[94:95], v[94:95]
    v_cvt_pk_bf16_f32 v200, v80, v81
    v_cvt_pk_bf16_f32 v201, v82, v83
    v_cvt_pk_bf16_f32 v202, v84, v85
    v_cvt_pk_bf16_f32 v203, v86, v87
    v_cvt_pk_bf16_f32 v204, v88, v89
    v_cvt_pk_bf16_f32 v205, v90, v91
    v_cvt_pk_bf16_f32 v206, v92, v93
    v_cvt_pk_bf16_f32 v207, v94, v95
    buffer_store_dwordx4 v[200:203], v2, s[68:71], s12 offen offset:1024 sc1
    buffer_store_dwordx4 v[204:207], v2, s[68:71], s12 offen offset:3072 sc1
    v_max_f32 v96, 0, v96
    v_max_f32 v97, 0, v97
    v_max_f32 v98, 0, v98
    v_max_f32 v99, 0, v99
    v_max_f32 v100, 0, v100
    v_max_f32 v101, 0, v101
    v_max_f32 v102, 0, v102
    v_max_f32 v103, 0, v103
    v_max_f32 v104, 0, v104
    v_max_f32 v105, 0, v105
    v_max_f32 v106, 0, v106
    v_max_f32 v107, 0, v107
    v_max_f32 v108, 0, v108
    v_max_f32 v109, 0, v109
    v_max_f32 v110, 0, v110
    v_max_f32 v111, 0, v111
    v_pk_mul_f32 v[96:97], v[96:97], v[96:97]
    v_pk_mul_f32 v[98:99], v[98:99], v[98:99]
    v_pk_mul_f32 v[100:101], v[100:101], v[100:101]
    v_pk_mul_f32 v[102:103], v[102:103], v[102:103]
    v_pk_mul_f32 v[104:105], v[104:105], v[104:105]
    v_pk_mul_f32 v[106:107], v[106:107], v[106:107]
    v_pk_mul_f32 v[108:109], v[108:109], v[108:109]
    v_pk_mul_f32 v[110:111], v[110:111], v[110:111]
    v_cvt_pk_bf16_f32 v208, v96, v97
    v_cvt_pk_bf16_f32 v209, v98, v99
    v_cvt_pk_bf16_f32 v210, v100, v101
    v_cvt_pk_bf16_f32 v211, v102, v103
    v_cvt_pk_bf16_f32 v212, v104, v105
    v_cvt_pk_bf16_f32 v213, v106, v107
    v_cvt_pk_bf16_f32 v214, v108, v109
    v_cvt_pk_bf16_f32 v215, v110, v111
    buffer_store_dwordx4 v[208:211], v2, s[68:71], s13 offen offset:0 sc1
    buffer_store_dwordx4 v[212:215], v2, s[68:71], s13 offen offset:2048 sc1
    v_max_f32 v112, 0, v112
    v_max_f32 v113, 0, v113
    v_max_f32 v114, 0, v114
    v_max_f32 v115, 0, v115
    v_max_f32 v116, 0, v116
    v_max_f32 v117, 0, v117
    v_max_f32 v118, 0, v118
    v_max_f32 v119, 0, v119
    v_max_f32 v120, 0, v120
    v_max_f32 v121, 0, v121
    v_max_f32 v122, 0, v122
    v_max_f32 v123, 0, v123
    v_max_f32 v124, 0, v124
    v_max_f32 v125, 0, v125
    v_max_f32 v126, 0, v126
    v_max_f32 v127, 0, v127
    v_pk_mul_f32 v[112:113], v[112:113], v[112:113]
    v_pk_mul_f32 v[114:115], v[114:115], v[114:115]
    v_pk_mul_f32 v[116:117], v[116:117], v[116:117]
    v_pk_mul_f32 v[118:119], v[118:119], v[118:119]
    v_pk_mul_f32 v[120:121], v[120:121], v[120:121]
    v_pk_mul_f32 v[122:123], v[122:123], v[122:123]
    v_pk_mul_f32 v[124:125], v[124:125], v[124:125]
    v_pk_mul_f32 v[126:127], v[126:127], v[126:127]
    v_cvt_pk_bf16_f32 v216, v112, v113
    v_cvt_pk_bf16_f32 v217, v114, v115
    v_cvt_pk_bf16_f32 v218, v116, v117
    v_cvt_pk_bf16_f32 v219, v118, v119
    v_cvt_pk_bf16_f32 v220, v120, v121
    v_cvt_pk_bf16_f32 v221, v122, v123
    v_cvt_pk_bf16_f32 v222, v124, v125
    v_cvt_pk_bf16_f32 v223, v126, v127
    s_waitcnt vmcnt(4)
    buffer_store_dwordx4 v[216:219], v2, s[68:71], s13 offen offset:1024 sc1
    buffer_store_dwordx4 v[220:223], v2, s[68:71], s13 offen offset:3072 sc1
L_G_noh:
    s_waitcnt vmcnt(0)
    s_mov_b64 exec, 1
    buffer_store_dword v8, off, s[68:71], s57 sc1
    s_mov_b64 exec, -1
    s_add_u32 m0, s14, 8192
    s_add_u32 s63, s52, s67
    s_bfe_u32 s54, s67, 0x10010
    s_mul_i32 s54, s54, 196608
    s_add_u32 s63, s63, s54
    buffer_load_dwordx4 v6, s[80:83], s63 offen lds
    buffer_load_dwordx4 v7, s[80:83], s63 offen offset:1024 lds
    s_add_u32 s67, s67, 16384
    s_and_b32 s67, s67, 0x1ffff
    s_add_u32 m0, s14, 10240
    s_add_u32 s63, s52, s67
    s_bfe_u32 s54, s67, 0x10010
    s_mul_i32 s54, s54, 196608
    s_add_u32 s63, s63, s54
    buffer_load_dwordx4 v6, s[80:83], s63 offen lds
    buffer_load_dwordx4 v7, s[80:83], s63 offen offset:1024 lds
    s_add_u32 s67, s67, 16384
    s_and_b32 s67, s67, 0x1ffff
    s_add_u32 m0, s14, 12288
    s_add_u32 s63, s52, s67
    s_bfe_u32 s54, s67, 0x10010
    s_mul_i32 s54, s54, 196608
    s_add_u32 s63, s63, s54
    buffer_load_dwordx4 v6, s[80:83], s63 offen lds
    buffer_load_dwordx4 v7, s[80:83], s63 offen offset:1024 lds
    s_add_u32 s67, s67, 16384
    s_and_b32 s67, s67, 0x1ffff
    v_mfma_f32_32x32x16_bf16 v[64:79], v[20:23], v[28:31], 0
    v_mfma_f32_32x32x16_bf16 v[80:95], v[20:23], v[28:31], 0
    v_mfma_f32_32x32x16_bf16 v[96:111], v[24:27], v[28:31], 0
    v_mfma_f32_32x32x16_bf16 v[112:127], v[24:27], v[28:31], 0
    s_waitcnt vmcnt(4)
    ds_read_b64_tr_b16 v[128:129], v54 offset:8192
    ds_read_b64_tr_b16 v[130:131], v54 offset:9216
    ds_read_b64_tr_b16 v[132:133], v55 offset:8192
    ds_read_b64_tr_b16 v[134:135], v55 offset:9216
    s_add_u32 m0, s14, 14336
    s_add_u32 s63, s52, s67
    s_bfe_u32 s54, s67, 0x10010
    s_mul_i32 s54, s54, 196608
    s_add_u32 s63, s63, s54
    buffer_load_dwordx4 v6, s[80:83], s63 offen lds
    buffer_load_dwordx4 v7, s[80:83], s63 offen offset:1024 lds
    s_add_u32 s67, s67, 16384
    s_and_b32 s67, s67, 0x1ffff
    s_waitcnt vmcnt(4)
    ds_read_b64_tr_b16 v[136:137], v54 offset:10240
    ds_read_b64_tr_b16 v[138:139], v54 offset:11264
    ds_read_b64_tr_b16 v[140:141], v55 offset:10240
    ds_read_b64_tr_b16 v[142:143], v55 offset:11264
    s_waitcnt lgkmcnt(4)
    s_add_u32 m0, s14, 8192
    s_add_u32 s63, s52, s67
    s_bfe_u32 s54, s67, 0x10010
    s_mul_i32 s54, s54, 196608
    s_add_u32 s63, s63, s54
    buffer_load_dwordx4 v6, s[80:83], s63 offen lds
    buffer_load_dwordx4 v7, s[80:83], s63 offen offset:1024 lds
    s_add_u32 s67, s67, 16384
    s_and_b32 s67, s67, 0x1ffff
    s_waitcnt vmcnt(4)
    ds_read_b64_tr_b16 v[144:145], v54 offset:12288
    ds_read_b64_tr_b16 v[146:147], v54 offset:13312
    ds_read_b64_tr_b16 v[148:149], v55 offset:12288
    ds_read_b64_tr_b16 v[150:151], v55 offset:13312
    s_waitcnt lgkmcnt(4)
    s_add_u32 m0, s14, 10240
    s_add_u32 s63, s52, s67
    s_bfe_u32 s54, s67, 0x10010
    s_mul_i32 s54, s54, 196608
    s_add_u32 s63, s63, s54
    buffer_load_dwordx4 v6, s[80:83], s63 offen lds
    buffer_load_dwordx4 v7, s[80:83], s63 offen offset:1024 lds
    s_add_u32 s67, s67, 16384
    s_and_b32 s67, s67, 0x1ffff
    s_waitcnt vmcnt(4)
    ds_read_b64_tr_b16 v[152:153], v54 offset:14336
    ds_read_b64_tr_b16 v[154:155], v54 offset:15360
    ds_read_b64_tr_b16 v[156:157], v55 offset:14336
    ds_read_b64_tr_b16 v[158:159], v55 offset:15360
    s_waitcnt lgkmcnt(4)
    s_add_u32 m0, s14, 12288
    s_add_u32 s63, s52, s67
    s_bfe_u32 s54, s67, 0x10010
    s_mul_i32 s54, s54, 196608
    s_add_u32 s63, s63, s54
    buffer_load_dwordx4 v6, s[80:83], s63 offen lds
    buffer_load_dwordx4 v7, s[80:83], s63 offen offset:1024 lds
    s_add_u32 s67, s67, 16384
    s_and_b32 s67, s67, 0x1ffff
    s_waitcnt vmcnt(4)
    ds_read_b64_tr_b16 v[160:161], v54 offset:8192
    ds_read_b64_tr_b16 v[162:163], v54 offset:9216
    ds_read_b64_tr_b16 v[164:165], v55 offset:8192
    ds_read_b64_tr_b16 v[166:167], v55 offset:9216
    s_waitcnt lgkmcnt(4)
    s_add_u32 m0, s14, 14336
    s_add_u32 s63, s52, s67
    s_bfe_u32 s54, s67, 0x10010
    s_mul_i32 s54, s54, 196608
    s_add_u32 s63, s63, s54
    buffer_load_dwordx4 v6, s[80:83], s63 offen lds
    buffer_load_dwordx4 v7, s[80:83], s63 offen offset:1024 lds
    s_add_u32 s67, s67, 16384
    s_and_b32 s67, s67, 0x1ffff
    s_waitcnt vmcnt(4)
    ds_read_b64_tr_b16 v[168:169], v54 offset:10240
    ds_read_b64_tr_b16 v[170:171], v54 offset:11264
    ds_read_b64_tr_b16 v[172:173], v55 offset:10240
    ds_read_b64_tr_b16 v[174:175], v55 offset:11264
    s_waitcnt lgkmcnt(4)
    s_add_u32 m0, s14, 0
    s_add_u32 s63, s66, 16384
    buffer_load_dwordx4 v6, s[76:79], s66 offen lds
    buffer_load_dwordx4 v7, s[76:79], s66 offen offset:1024 lds
    s_cmp_eq_u32 s63, s62
    s_cselect_b32 s66, s61, s63
    s_waitcnt vmcnt(4)
    ds_read_b64_tr_b16 v[176:177], v54 offset:12288
    ds_read_b64_tr_b16 v[178:179], v54 offset:13312
    ds_read_b64_tr_b16 v[180:181], v55 offset:12288
    ds_read_b64_tr_b16 v[182:183], v55 offset:13312
    s_waitcnt lgkmcnt(4)
    s_add_u32 m0, s14, 2048
    s_add_u32 s63, s66, 16384
    buffer_load_dwordx4 v6, s[76:79], s66 offen lds
    buffer_load_dwordx4 v7, s[76:79], s66 offen offset:1024 lds
    s_cmp_eq_u32 s63, s62
    s_cselect_b32 s66, s61, s63
    s_waitcnt vmcnt(4)
    ds_read_b64_tr_b16 v[184:185], v54 offset:14336
    ds_read_b64_tr_b16 v[186:187], v54 offset:15360
    ds_read_b64_tr_b16 v[188:189], v55 offset:14336
    ds_read_b64_tr_b16 v[190:191], v55 offset:15360
    s_waitcnt lgkmcnt(4)
    s_add_u32 m0, s14, 4096
    s_add_u32 s63, s66, 16384
    buffer_load_dwordx4 v6, s[76:79], s66 offen lds
    buffer_load_dwordx4 v7, s[76:79], s66 offen offset:1024 lds
    s_cmp_eq_u32 s63, s62
    s_cselect_b32 s66, s61, s63
    s_waitcnt lgkmcnt(0)
    s_add_u32 m0, s14, 6144
    s_add_u32 s63, s66, 16384
    buffer_load_dwordx4 v6, s[76:79], s66 offen lds
    buffer_load_dwordx4 v7, s[76:79], s66 offen offset:1024 lds
    s_cmp_eq_u32 s63, s62
    s_cselect_b32 s66, s61, s63
L_hpoll:
    buffer_load_dword v15, v14, s[68:71], s11 offen sc1
    s_waitcnt vmcnt(0)
    v_cmp_ne_u32 vcc, s59, v15
    s_cbranch_vccz L_hok
    s_sub_u32 s99, s99, 1
    s_cmp_le_i32 s99, 0
    s_cbranch_scc1 L_hok
    s_sleep 4
    s_branch L_hpoll
L_hok:
    buffer_load_dwordx4 v[192:195], v2, s[68:71], s9 offen offset:0 sc1
    buffer_load_dwordx4 v[196:199], v2, s[68:71], s9 offen offset:1024 sc1
    s_add_u32 s9, s9, 2048
    s_cmp_eq_u32 s9, s65
    s_cselect_b32 s9, s64, s9
    buffer_load_dwordx4 v[200:203], v2, s[68:71], s9 offen offset:0 sc1
    buffer_load_dwordx4 v[204:207], v2, s[68:71], s9 offen offset:1024 sc1
    s_add_u32 s9, s9, 2048
    s_cmp_eq_u32 s9, s65
    s_cselect_b32 s9, s64, s9
    s_lshl_b32 s12, s4, 3
    s_add_u32 s12, s12, s6
    s_lshl_b32 s12, s12, 13
    s_add_u32 s12, s12, 262144
    s_mov_b32 s8, s12
    s_add_u32 s11, s55, 0
    s_and_b32 s11, s11, 3
    s_lshr_b32 s54, s11, 1
    s_mul_i32 s54, s54, 6
    s_add_u32 s11, s11, s54
    s_lshl_b32 s11, s11, 12
    s_add_u32 s12, s8, s11
    s_add_u32 s11, s55, 1
    s_and_b32 s11, s11, 3
    s_lshr_b32 s54, s11, 1
    s_mul_i32 s54, s54, 6
    s_add_u32 s11, s11, s54
    s_lshl_b32 s11, s11, 12
    s_add_u32 s56, s8, s11
    s_add_u32 s11, s55, 2
    s_and_b32 s11, s11, 3
    s_lshr_b32 s54, s11, 1
    s_mul_i32 s54, s54, 6
    s_add_u32 s11, s11, s54
    s_lshl_b32 s11, s11, 12
    s_add_u32 s57, s8, s11
    s_add_u32 s11, s55, 3
    s_and_b32 s11, s11, 3
    s_lshr_b32 s54, s11, 1
    s_mul_i32 s54, s54, 6
    s_add_u32 s11, s11, s54
    s_lshl_b32 s11, s11, 12
    s_add_u32 s13, s8, s11
    s_lshl_b32 s72, s4, 9
    s_add_u32 s72, s72, 196608
    s_and_b32 s73, s5, 3
    s_lshl_b32 s73, s73, 7
    s_lshr_b32 s74, s5, 2
    s_lshl_b32 s74, s74, 2
    s_add_u32 s73, s73, s74
    s_add_u32 s73, s73, s72
    s_lshl_b32 s74, s6, 7
    s_add_u32 s72, s72, s74
    v_and_b32 v23, 1, v0
    v_lshlrev_b32 v23, 2, v23
    v_mov_b32 v22, s59
    v_lshrrev_b32 v10, 3, v0
    s_lshl_b32 s10, s3, 3
    v_add_u32 v10, s10, v10
    v_and_b32 v11, 7, v0
    v_mul_u32_u24 v8, 272, v10
    v_lshl_add_u32 v8, v11, 5, v8
    v_add_u32 v8, 65536, v8
    v_add_u32 v9, 34816, v8
    v_lshlrev_b32 v10, 10, v10
    v_lshl_add_u32 v10, v11, 4, v10
    s_lshl_b32 s10, s4, 16
    s_lshl_b32 s11, s5, 7
    s_add_u32 s10, s10, s11
    s_mov_b32 s84, s38
    s_mov_b32 s85, s39
    s_mov_b32 s86, 0x200000
    s_mov_b32 s87, 0x20000
    v_and_b32 v14, 31, v0
    v_lshlrev_b32 v3, 2, v14
    v_add_u32 v3, 151552, v3
    v_mul_u32_u24 v14, 272, v14
    v_lshrrev_b32 v15, 5, v0
    v_lshl_add_u32 v14, v15, 4, v14
    v_add_u32 v14, s14, v14
    s_setprio 0
    ds_read_b64_tr_b16 v[32:33], v54 offset:0
    ds_read_b64_tr_b16 v[34:35], v54 offset:1024
    ds_read_b64_tr_b16 v[36:37], v55 offset:0
    ds_read_b64_tr_b16 v[38:39], v55 offset:1024
    s_waitcnt vmcnt(2) lgkmcnt(0)
    v_mfma_f32_32x32x16_bf16 v[64:79], v[32:35], v[192:195], v[64:79]
    ds_read_b64_tr_b16 v[40:41], v54 offset:2048
    ds_read_b64_tr_b16 v[42:43], v54 offset:3072
    v_mfma_f32_32x32x16_bf16 v[80:95], v[32:35], v[196:199], v[80:95]
    ds_read_b64_tr_b16 v[44:45], v55 offset:2048
    ds_read_b64_tr_b16 v[46:47], v55 offset:3072
    v_mfma_f32_32x32x16_bf16 v[96:111], v[36:39], v[192:195], v[96:111]
    v_mfma_f32_32x32x16_bf16 v[112:127], v[36:39], v[196:199], v[112:127]
    buffer_load_dwordx4 v[208:211], v2, s[68:71], s9 offen offset:0 sc1
    buffer_load_dwordx4 v[212:215], v2, s[68:71], s9 offen offset:1024 sc1
    s_add_u32 s9, s9, 2048
    s_cmp_eq_u32 s9, s65
    s_cselect_b32 s9, s64, s9
    s_add_u32 m0, s14, 8192
    s_add_u32 s63, s66, 16384
    buffer_load_dwordx4 v6, s[76:79], s66 offen lds
    buffer_load_dwordx4 v7, s[76:79], s66 offen offset:1024 lds
    s_cmp_eq_u32 s63, s62
    s_cselect_b32 s66, s61, s63
    s_waitcnt vmcnt(4) lgkmcnt(0)
    v_mfma_f32_32x32x16_bf16 v[64:79], v[40:43], v[200:203], v[64:79]
    ds_read_b64_tr_b16 v[32:33], v54 offset:4096
    ds_read_b64_tr_b16 v[34:35], v54 offset:5120
    v_mfma_f32_32x32x16_bf16 v[80:95], v[40:43], v[204:207], v[80:95]
    ds_read_b64_tr_b16 v[36:37], v55 offset:4096
    ds_read_b64_tr_b16 v[38:39], v55 offset:5120
    v_mfma_f32_32x32x16_bf16 v[96:111], v[44:47], v[200:203], v[96:111]
    v_mfma_f32_32x32x16_bf16 v[112:127], v[44:47], v[204:207], v[112:127]
    buffer_load_dwordx4 v[216:219], v2, s[68:71], s9 offen offset:0 sc1
    buffer_load_dwordx4 v[220:223], v2, s[68:71], s9 offen offset:1024 sc1
    s_add_u32 s9, s9, 2048
    s_cmp_eq_u32 s9, s65
    s_cselect_b32 s9, s64, s9
    s_add_u32 m0, s14, 10240
    s_add_u32 s63, s66, 16384
    buffer_load_dwordx4 v6, s[76:79], s66 offen lds
    buffer_load_dwordx4 v7, s[76:79], s66 offen offset:1024 lds
    s_cmp_eq_u32 s63, s62
    s_cselect_b32 s66, s61, s63
    s_waitcnt vmcnt(6) lgkmcnt(0)
    v_mfma_f32_32x32x16_bf16 v[64:79], v[32:35], v[208:211], v[64:79]
    ds_read_b64_tr_b16 v[40:41], v54 offset:6144
    ds_read_b64_tr_b16 v[42:43], v54 offset:7168
    v_mfma_f32_32x32x16_bf16 v[80:95], v[32:35], v[212:215], v[80:95]
    ds_read_b64_tr_b16 v[44:45], v55 offset:6144
    ds_read_b64_tr_b16 v[46:47], v55 offset:7168
    v_mfma_f32_32x32x16_bf16 v[96:111], v[36:39], v[208:211], v[96:111]
    v_mfma_f32_32x32x16_bf16 v[112:127], v[36:39], v[212:215], v[112:127]
    buffer_load_dwordx4 v[224:227], v2, s[68:71], s9 offen offset:0 sc1
    buffer_load_dwordx4 v[228:231], v2, s[68:71], s9 offen offset:1024 sc1
    s_add_u32 s9, s9, 2048
    s_cmp_eq_u32 s9, s65
    s_cselect_b32 s9, s64, s9
    s_add_u32 m0, s14, 12288
    s_add_u32 s63, s66, 16384
    buffer_load_dwordx4 v6, s[76:79], s66 offen lds
    buffer_load_dwordx4 v7, s[76:79], s66 offen offset:1024 lds
    s_cmp_eq_u32 s63, s62
    s_cselect_b32 s66, s61, s63
    s_waitcnt vmcnt(6) lgkmcnt(0)
    v_mfma_f32_32x32x16_bf16 v[64:79], v[40:43], v[216:219], v[64:79]
    ds_read_b64_tr_b16 v[32:33], v54 offset:8192
    ds_read_b64_tr_b16 v[34:35], v54 offset:9216
    v_mfma_f32_32x32x16_bf16 v[80:95], v[40:43], v[220:223], v[80:95]
    ds_read_b64_tr_b16 v[36:37], v55 offset:8192
    ds_read_b64_tr_b16 v[38:39], v55 offset:9216
    v_mfma_f32_32x32x16_bf16 v[96:111], v[44:47], v[216:219], v[96:111]
    v_mfma_f32_32x32x16_bf16 v[112:127], v[44:47], v[220:223], v[112:127]
    buffer_load_dwordx4 v[232:235], v2, s[68:71], s9 offen offset:0 sc1
    buffer_load_dwordx4 v[236:239], v2, s[68:71], s9 offen offset:1024 sc1
    s_add_u32 s9, s9, 2048
    s_cmp_eq_u32 s9, s65
    s_cselect_b32 s9, s64, s9
    s_add_u32 m0, s14, 14336
    s_add_u32 s63, s66, 16384
    buffer_load_dwordx4 v6, s[76:79], s66 offen lds
    buffer_load_dwordx4 v7, s[76:79], s66 offen offset:1024 lds
    s_cmp_eq_u32 s63, s62
    s_cselect_b32 s66, s61, s63
    s_waitcnt vmcnt(6) lgkmcnt(0)
    v_mfma_f32_32x32x16_bf16 v[64:79], v[32:35], v[224:227], v[64:79]
    ds_read_b64_tr_b16 v[40:41], v54 offset:10240
    ds_read_b64_tr_b16 v[42:43], v54 offset:11264
    v_mfma_f32_32x32x16_bf16 v[80:95], v[32:35], v[228:231], v[80:95]
    ds_read_b64_tr_b16 v[44:45], v55 offset:10240
    ds_read_b64_tr_b16 v[46:47], v55 offset:11264
    v_mfma_f32_32x32x16_bf16 v[96:111], v[36:39], v[224:227], v[96:111]
    v_mfma_f32_32x32x16_bf16 v[112:127], v[36:39], v[228:231], v[112:127]
    buffer_load_dwordx4 v[240:243], v2, s[68:71], s9 offen offset:0 sc1
    buffer_load_dwordx4 v[244:247], v2, s[68:71], s9 offen offset:1024 sc1
    s_add_u32 s9, s9, 2048
    s_cmp_eq_u32 s9, s65
    s_cselect_b32 s9, s64, s9
    s_add_u32 m0, s14, 0
    s_add_u32 s63, s66, 16384
    buffer_load_dwordx4 v6, s[76:79], s66 offen lds
    buffer_load_dwordx4 v7, s[76:79], s66 offen offset:1024 lds
    s_cmp_eq_u32 s63, s62
    s_cselect_b32 s66, s61, s63
    s_waitcnt vmcnt(6) lgkmcnt(0)
    v_mfma_f32_32x32x16_bf16 v[64:79], v[40:43], v[232:235], v[64:79]
    ds_read_b64_tr_b16 v[32:33], v54 offset:12288
    ds_read_b64_tr_b16 v[34:35], v54 offset:13312
    v_mfma_f32_32x32x16_bf16 v[80:95], v[40:43], v[236:239], v[80:95]
    ds_read_b64_tr_b16 v[36:37], v55 offset:12288
    ds_read_b64_tr_b16 v[38:39], v55 offset:13312
    v_mfma_f32_32x32x16_bf16 v[96:111], v[44:47], v[232:235], v[96:111]
    v_mfma_f32_32x32x16_bf16 v[112:127], v[44:47], v[236:239], v[112:127]
    buffer_load_dwordx4 v[248:251], v2, s[68:71], s9 offen offset:0 sc1
    buffer_load_dwordx4 v[252:255], v2, s[68:71], s9 offen offset:1024 sc1
    s_add_u32 s9, s9, 2048
    s_cmp_eq_u32 s9, s65
    s_cselect_b32 s9, s64, s9
    s_add_u32 m0, s14, 2048
    s_add_u32 s63, s66, 16384
    buffer_load_dwordx4 v6, s[76:79], s66 offen lds
    buffer_load_dwordx4 v7, s[76:79], s66 offen offset:1024 lds
    s_cmp_eq_u32 s63, s62
    s_cselect_b32 s66, s61, s63
    s_waitcnt vmcnt(6) lgkmcnt(0)
    v_mfma_f32_32x32x16_bf16 v[64:79], v[32:35], v[240:243], v[64:79]
    ds_read_b64_tr_b16 v[40:41], v54 offset:14336
    ds_read_b64_tr_b16 v[42:43], v54 offset:15360
    v_mfma_f32_32x32x16_bf16 v[80:95], v[32:35], v[244:247], v[80:95]
    ds_read_b64_tr_b16 v[44:45], v55 offset:14336
    ds_read_b64_tr_b16 v[46:47], v55 offset:15360
    v_mfma_f32_32x32x16_bf16 v[96:111], v[36:39], v[240:243], v[96:111]
    v_mfma_f32_32x32x16_bf16 v[112:127], v[36:39], v[244:247], v[112:127]
    buffer_load_dwordx4 v[192:195], v2, s[68:71], s9 offen offset:0 sc1
    buffer_load_dwordx4 v[196:199], v2, s[68:71], s9 offen offset:1024 sc1
    s_add_u32 s9, s9, 2048
    s_cmp_eq_u32 s9, s65
    s_cselect_b32 s9, s64, s9
    s_add_u32 m0, s14, 4096
    s_add_u32 s63, s66, 16384
    buffer_load_dwordx4 v6, s[76:79], s66 offen lds
    buffer_load_dwordx4 v7, s[76:79], s66 offen offset:1024 lds
    s_cmp_eq_u32 s63, s62
    s_cselect_b32 s66, s61, s63
    s_waitcnt vmcnt(6) lgkmcnt(0)
    v_mfma_f32_32x32x16_bf16 v[64:79], v[40:43], v[248:251], v[64:79]
    ds_read_b64_tr_b16 v[32:33], v54 offset:0
    ds_read_b64_tr_b16 v[34:35], v54 offset:1024
    v_mfma_f32_32x32x16_bf16 v[80:95], v[40:43], v[252:255], v[80:95]
    ds_read_b64_tr_b16 v[36:37], v55 offset:0
    ds_read_b64_tr_b16 v[38:39], v55 offset:1024
    v_mfma_f32_32x32x16_bf16 v[96:111], v[44:47], v[248:251], v[96:111]
    v_mfma_f32_32x32x16_bf16 v[112:127], v[44:47], v[252:255], v[112:127]
    buffer_load_dwordx4 v[200:203], v2, s[68:71], s9 offen offset:0 sc1
    buffer_load_dwordx4 v[204:207], v2, s[68:71], s9 offen offset:1024 sc1
    s_add_u32 s9, s9, 2048
    s_cmp_eq_u32 s9, s65
    s_cselect_b32 s9, s64, s9
    s_add_u32 m0, s14, 6144
    s_add_u32 s63, s66, 16384
    buffer_load_dwordx4 v6, s[76:79], s66 offen lds
    buffer_load_dwordx4 v7, s[76:79], s66 offen offset:1024 lds
    s_cmp_eq_u32 s63, s62
    s_cselect_b32 s66, s61, s63
    s_waitcnt vmcnt(6) lgkmcnt(0)
    v_mfma_f32_32x32x16_bf16 v[64:79], v[32:35], v[192:195], v[64:79]
    ds_read_b64_tr_b16 v[40:41], v54 offset:2048
    ds_read_b64_tr_b16 v[42:43], v54 offset:3072
    v_mfma_f32_32x32x16_bf16 v[80:95], v[32:35], v[196:199], v[80:95]
    ds_read_b64_tr_b16 v[44:45], v55 offset:2048
    ds_read_b64_tr_b16 v[46:47], v55 offset:3072
    v_mfma_f32_32x32x16_bf16 v[96:111], v[36:39], v[192:195], v[96:111]
    v_mfma_f32_32x32x16_bf16 v[112:127], v[36:39], v[196:199], v[112:127]
    buffer_load_dwordx4 v[208:211], v2, s[68:71], s9 offen offset:0 sc1
    buffer_load_dwordx4 v[212:215], v2, s[68:71], s9 offen offset:1024 sc1
    s_add_u32 s9, s9, 2048
    s_cmp_eq_u32 s9, s65
    s_cselect_b32 s9, s64, s9
    s_add_u32 m0, s14, 8192
    s_add_u32 s63, s66, 16384
    buffer_load_dwordx4 v6, s[76:79], s66 offen lds
    buffer_load_dwordx4 v7, s[76:79], s66 offen offset:1024 lds
    s_cmp_eq_u32 s63, s62
    s_cselect_b32 s66, s61, s63
    s_waitcnt vmcnt(6) lgkmcnt(0)
    v_mfma_f32_32x32x16_bf16 v[64:79], v[40:43], v[200:203], v[64:79]
    ds_read_b64_tr_b16 v[32:33], v54 offset:4096
    ds_read_b64_tr_b16 v[34:35], v54 offset:5120
    v_mfma_f32_32x32x16_bf16 v[80:95], v[40:43], v[204:207], v[80:95]
    ds_read_b64_tr_b16 v[36:37], v55 offset:4096
    ds_read_b64_tr_b16 v[38:39], v55 offset:5120
    v_mfma_f32_32x32x16_bf16 v[96:111], v[44:47], v[200:203], v[96:111]
    v_mfma_f32_32x32x16_bf16 v[112:127], v[44:47], v[204:207], v[112:127]
    buffer_load_dwordx4 v[216:219], v2, s[68:71], s9 offen offset:0 sc1
    buffer_load_dwordx4 v[220:223], v2, s[68:71], s9 offen offset:1024 sc1
    s_add_u32 s9, s9, 2048
    s_cmp_eq_u32 s9, s65
    s_cselect_b32 s9, s64, s9
    s_add_u32 m0, s14, 10240
    s_add_u32 s63, s66, 16384
    buffer_load_dwordx4 v6, s[76:79], s66 offen lds
    buffer_load_dwordx4 v7, s[76:79], s66 offen offset:1024 lds
    s_cmp_eq_u32 s63, s62
    s_cselect_b32 s66, s61, s63
    s_waitcnt vmcnt(6) lgkmcnt(0)
    v_mfma_f32_32x32x16_bf16 v[64:79], v[32:35], v[208:211], v[64:79]
    ds_read_b64_tr_b16 v[40:41], v54 offset:6144
    ds_read_b64_tr_b16 v[42:43], v54 offset:7168
    v_mfma_f32_32x32x16_bf16 v[80:95], v[32:35], v[212:215], v[80:95]
    ds_read_b64_tr_b16 v[44:45], v55 offset:6144
    ds_read_b64_tr_b16 v[46:47], v55 offset:7168
    v_mfma_f32_32x32x16_bf16 v[96:111], v[36:39], v[208:211], v[96:111]
    v_mfma_f32_32x32x16_bf16 v[112:127], v[36:39], v[212:215], v[112:127]
    buffer_load_dwordx4 v[224:227], v2, s[68:71], s9 offen offset:0 sc1
    buffer_load_dwordx4 v[228:231], v2, s[68:71], s9 offen offset:1024 sc1
    s_add_u32 s9, s9, 2048
    s_cmp_eq_u32 s9, s65
    s_cselect_b32 s9, s64, s9
    s_add_u32 m0, s14, 12288
    s_add_u32 s63, s66, 16384
    buffer_load_dwordx4 v6, s[76:79], s66 offen lds
    buffer_load_dwordx4 v7, s[76:79], s66 offen offset:1024 lds
    s_cmp_eq_u32 s63, s62
    s_cselect_b32 s66, s61, s63
    s_waitcnt vmcnt(6) lgkmcnt(0)
    v_mfma_f32_32x32x16_bf16 v[64:79], v[40:43], v[216:219], v[64:79]
    ds_read_b64_tr_b16 v[32:33], v54 offset:8192
    ds_read_b64_tr_b16 v[34:35], v54 offset:9216
    v_mfma_f32_32x32x16_bf16 v[80:95], v[40:43], v[220:223], v[80:95]
    ds_read_b64_tr_b16 v[36:37], v55 offset:8192
    ds_read_b64_tr_b16 v[38:39], v55 offset:9216
    v_mfma_f32_32x32x16_bf16 v[96:111], v[44:47], v[216:219], v[96:111]
    v_mfma_f32_32x32x16_bf16 v[112:127], v[44:47], v[220:223], v[112:127]
    buffer_load_dwordx4 v[232:235], v2, s[68:71], s9 offen offset:0 sc1
    buffer_load_dwordx4 v[236:239], v2, s[68:71], s9 offen offset:1024 sc1
    s_add_u32 s9, s9, 2048
    s_cmp_eq_u32 s9, s65
    s_cselect_b32 s9, s64, s9
    s_add_u32 m0, s14, 14336
    s_add_u32 s63, s66, 16384
    buffer_load_dwordx4 v6, s[76:79], s66 offen lds
    buffer_load_dwordx4 v7, s[76:79], s66 offen offset:1024 lds
    s_cmp_eq_u32 s63, s62
    s_cselect_b32 s66, s61, s63
    s_waitcnt vmcnt(6) lgkmcnt(0)
    v_mfma_f32_32x32x16_bf16 v[64:79], v[32:35], v[224:227], v[64:79]
    ds_read_b64_tr_b16 v[40:41], v54 offset:10240
    ds_read_b64_tr_b16 v[42:43], v54 offset:11264
    v_mfma_f32_32x32x16_bf16 v[80:95], v[32:35], v[228:231], v[80:95]
    ds_read_b64_tr_b16 v[44:45], v55 offset:10240
    ds_read_b64_tr_b16 v[46:47], v55 offset:11264
    v_mfma_f32_32x32x16_bf16 v[96:111], v[36:39], v[224:227], v[96:111]
    v_mfma_f32_32x32x16_bf16 v[112:127], v[36:39], v[228:231], v[112:127]
    buffer_load_dwordx4 v[240:243], v2, s[68:71], s9 offen offset:0 sc1
    buffer_load_dwordx4 v[244:247], v2, s[68:71], s9 offen offset:1024 sc1
    s_add_u32 s9, s9, 2048
    s_cmp_eq_u32 s9, s65
    s_cselect_b32 s9, s64, s9
    s_add_u32 m0, s14, 0
    s_add_u32 s63, s66, 16384
    buffer_load_dwordx4 v6, s[76:79], s66 offen lds
    buffer_load_dwordx4 v7, s[76:79], s66 offen offset:1024 lds
    s_cmp_eq_u32 s63, s62
    s_cselect_b32 s66, s61, s63
    s_waitcnt vmcnt(6) lgkmcnt(0)
    v_mfma_f32_32x32x16_bf16 v[64:79], v[40:43], v[232:235], v[64:79]
    ds_read_b64_tr_b16 v[32:33], v54 offset:12288
    ds_read_b64_tr_b16 v[34:35], v54 offset:13312
    v_mfma_f32_32x32x16_bf16 v[80:95], v[40:43], v[236:239], v[80:95]
    ds_read_b64_tr_b16 v[36:37], v55 offset:12288
    ds_read_b64_tr_b16 v[38:39], v55 offset:13312
    v_mfma_f32_32x32x16_bf16 v[96:111], v[44:47], v[232:235], v[96:111]
    v_mfma_f32_32x32x16_bf16 v[112:127], v[44:47], v[236:239], v[112:127]
    buffer_load_dwordx4 v[248:251], v2, s[68:71], s9 offen offset:0 sc1
    buffer_load_dwordx4 v[252:255], v2, s[68:71], s9 offen offset:1024 sc1
    s_add_u32 s9, s9, 2048
    s_cmp_eq_u32 s9, s65
    s_cselect_b32 s9, s64, s9
    s_add_u32 m0, s14, 2048
    s_add_u32 s63, s66, 16384
    buffer_load_dwordx4 v6, s[76:79], s66 offen lds
    buffer_load_dwordx4 v7, s[76:79], s66 offen offset:1024 lds
    s_cmp_eq_u32 s63, s62
    s_cselect_b32 s66, s61, s63
    s_waitcnt vmcnt(6) lgkmcnt(0)
    v_mfma_f32_32x32x16_bf16 v[64:79], v[32:35], v[240:243], v[64:79]
    ds_read_b64_tr_b16 v[40:41], v54 offset:14336
    ds_read_b64_tr_b16 v[42:43], v54 offset:15360
    v_mfma_f32_32x32x16_bf16 v[80:95], v[32:35], v[244:247], v[80:95]
    ds_read_b64_tr_b16 v[44:45], v55 offset:14336
    ds_read_b64_tr_b16 v[46:47], v55 offset:15360
    v_mfma_f32_32x32x16_bf16 v[96:111], v[36:39], v[240:243], v[96:111]
    v_mfma_f32_32x32x16_bf16 v[112:127], v[36:39], v[244:247], v[112:127]
    buffer_load_dwordx4 v[192:195], v2, s[68:71], s9 offen offset:0 sc1
    buffer_load_dwordx4 v[196:199], v2, s[68:71], s9 offen offset:1024 sc1
    s_add_u32 s9, s9, 2048
    s_cmp_eq_u32 s9, s65
    s_cselect_b32 s9, s64, s9
    s_add_u32 m0, s14, 4096
    s_add_u32 s63, s66, 16384
    buffer_load_dwordx4 v6, s[76:79], s66 offen lds
    buffer_load_dwordx4 v7, s[76:79], s66 offen offset:1024 lds
    s_cmp_eq_u32 s63, s62
    s_cselect_b32 s66, s61, s63
    s_waitcnt vmcnt(6) lgkmcnt(0)
    v_mfma_f32_32x32x16_bf16 v[64:79], v[40:43], v[248:251], v[64:79]
    ds_read_b64_tr_b16 v[32:33], v54 offset:0
    ds_read_b64_tr_b16 v[34:35], v54 offset:1024
    v_mfma_f32_32x32x16_bf16 v[80:95], v[40:43], v[252:255], v[80:95]
    ds_read_b64_tr_b16 v[36:37], v55 offset:0
    ds_read_b64_tr_b16 v[38:39], v55 offset:1024
    v_mfma_f32_32x32x16_bf16 v[96:111], v[44:47], v[248:251], v[96:111]
    v_mfma_f32_32x32x16_bf16 v[112:127], v[44:47], v[252:255], v[112:127]
    buffer_load_dwordx4 v[200:203], v2, s[68:71], s9 offen offset:0 sc1
    buffer_load_dwordx4 v[204:207], v2, s[68:71], s9 offen offset:1024 sc1
    s_add_u32 s9, s9, 2048
    s_cmp_eq_u32 s9, s65
    s_cselect_b32 s9, s64, s9
    s_add_u32 m0, s14, 6144
    s_add_u32 s63, s66, 16384
    buffer_load_dwordx4 v6, s[76:79], s66 offen lds
    buffer_load_dwordx4 v7, s[76:79], s66 offen offset:1024 lds
    s_cmp_eq_u32 s63, s62
    s_cselect_b32 s66, s61, s63
    s_waitcnt vmcnt(6) lgkmcnt(0)
    v_mfma_f32_32x32x16_bf16 v[64:79], v[32:35], v[192:195], v[64:79]
    ds_read_b64_tr_b16 v[40:41], v54 offset:2048
    ds_read_b64_tr_b16 v[42:43], v54 offset:3072
    v_mfma_f32_32x32x16_bf16 v[80:95], v[32:35], v[196:199], v[80:95]
    ds_read_b64_tr_b16 v[44:45], v55 offset:2048
    ds_read_b64_tr_b16 v[46:47], v55 offset:3072
    v_mfma_f32_32x32x16_bf16 v[96:111], v[36:39], v[192:195], v[96:111]
    v_mfma_f32_32x32x16_bf16 v[112:127], v[36:39], v[196:199], v[112:127]
    buffer_load_dwordx4 v[208:211], v2, s[68:71], s9 offen offset:0 sc1
    buffer_load_dwordx4 v[212:215], v2, s[68:71], s9 offen offset:1024 sc1
    s_add_u32 s9, s9, 2048
    s_cmp_eq_u32 s9, s65
    s_cselect_b32 s9, s64, s9
    s_add_u32 m0, s14, 8192
    s_add_u32 s63, s66, 16384
    buffer_load_dwordx4 v6, s[76:79], s66 offen lds
    buffer_load_dwordx4 v7, s[76:79], s66 offen offset:1024 lds
    s_cmp_eq_u32 s63, s62
    s_cselect_b32 s66, s61, s63
    s_waitcnt vmcnt(6) lgkmcnt(0)
    v_mfma_f32_32x32x16_bf16 v[64:79], v[40:43], v[200:203], v[64:79]
    ds_read_b64_tr_b16 v[32:33], v54 offset:4096
    ds_read_b64_tr_b16 v[34:35], v54 offset:5120
    v_mfma_f32_32x32x16_bf16 v[80:95], v[40:43], v[204:207], v[80:95]
    ds_read_b64_tr_b16 v[36:37], v55 offset:4096
    ds_read_b64_tr_b16 v[38:39], v55 offset:5120
    v_mfma_f32_32x32x16_bf16 v[96:111], v[44:47], v[200:203], v[96:111]
    v_mfma_f32_32x32x16_bf16 v[112:127], v[44:47], v[204:207], v[112:127]
    buffer_load_dwordx4 v[216:219], v2, s[68:71], s9 offen offset:0 sc1
    buffer_load_dwordx4 v[220:223], v2, s[68:71], s9 offen offset:1024 sc1
    s_add_u32 s9, s9, 2048
    s_cmp_eq_u32 s9, s65
    s_cselect_b32 s9, s64, s9
    s_add_u32 m0, s14, 10240
    s_add_u32 s63, s66, 16384
    buffer_load_dwordx4 v6, s[76:79], s66 offen lds
    buffer_load_dwordx4 v7, s[76:79], s66 offen offset:1024 lds
    s_cmp_eq_u32 s63, s62
    s_cselect_b32 s66, s61, s63
    s_waitcnt vmcnt(6) lgkmcnt(0)
    v_mfma_f32_32x32x16_bf16 v[64:79], v[32:35], v[208:211], v[64:79]
    ds_read_b64_tr_b16 v[40:41], v54 offset:6144
    ds_read_b64_tr_b16 v[42:43], v54 offset:7168
    v_mfma_f32_32x32x16_bf16 v[80:95], v[32:35], v[212:215], v[80:95]
    ds_read_b64_tr_b16 v[44:45], v55 offset:6144
    ds_read_b64_tr_b16 v[46:47], v55 offset:7168
    v_mfma_f32_32x32x16_bf16 v[96:111], v[36:39], v[208:211], v[96:111]
    v_mfma_f32_32x32x16_bf16 v[112:127], v[36:39], v[212:215], v[112:127]
    buffer_load_dwordx4 v[224:227], v2, s[68:71], s9 offen offset:0 sc1
    buffer_load_dwordx4 v[228:231], v2, s[68:71], s9 offen offset:1024 sc1
    s_add_u32 s9, s9, 2048
    s_cmp_eq_u32 s9, s65
    s_cselect_b32 s9, s64, s9
    s_add_u32 m0, s14, 12288
    s_add_u32 s63, s66, 16384
    buffer_load_dwordx4 v6, s[76:79], s66 offen lds
    buffer_load_dwordx4 v7, s[76:79], s66 offen offset:1024 lds
    s_cmp_eq_u32 s63, s62
    s_cselect_b32 s66, s61, s63
    s_waitcnt vmcnt(6) lgkmcnt(0)
    v_mfma_f32_32x32x16_bf16 v[64:79], v[40:43], v[216:219], v[64:79]
    v_mfma_f32_32x32x16_bf16 v[80:95], v[40:43], v[220:223], v[80:95]
    v_mfma_f32_32x32x16_bf16 v[96:111], v[44:47], v[216:219], v[96:111]
    v_mfma_f32_32x32x16_bf16 v[112:127], v[44:47], v[220:223], v[112:127]
    buffer_load_dwordx4 v[232:235], v2, s[68:71], s9 offen offset:0 sc1
    buffer_load_dwordx4 v[236:239], v2, s[68:71], s9 offen offset:1024 sc1
    s_add_u32 s9, s9, 2048
    s_cmp_eq_u32 s9, s65
    s_cselect_b32 s9, s64, s9
    s_add_u32 m0, s14, 14336
    s_add_u32 s63, s66, 16384
    buffer_load_dwordx4 v6, s[76:79], s66 offen lds
    buffer_load_dwordx4 v7, s[76:79], s66 offen offset:1024 lds
    s_cmp_eq_u32 s63, s62
    s_cselect_b32 s66, s61, s63
    s_waitcnt vmcnt(6)
    buffer_load_dwordx4 v[240:243], v2, s[68:71], s9 offen offset:0 sc1
    buffer_load_dwordx4 v[244:247], v2, s[68:71], s9 offen offset:1024 sc1
    s_add_u32 s9, s9, 2048
    s_cmp_eq_u32 s9, s65
    s_cselect_b32 s9, s64, s9
    s_add_u32 m0, s14, 0
    s_add_u32 s63, s66, 16384
    buffer_load_dwordx4 v6, s[76:79], s66 offen lds
    buffer_load_dwordx4 v7, s[76:79], s66 offen offset:1024 lds
    s_cmp_eq_u32 s63, s62
    s_cselect_b32 s66, s61, s63
    s_waitcnt vmcnt(6)
    buffer_load_dwordx4 v[248:251], v2, s[68:71], s9 offen offset:0 sc1
    buffer_load_dwordx4 v[252:255], v2, s[68:71], s9 offen offset:1024 sc1
    s_add_u32 s9, s9, 2048
    s_cmp_eq_u32 s9, s65
    s_cselect_b32 s9, s64, s9
    s_add_u32 m0, s14, 2048
    s_add_u32 s63, s66, 16384
    buffer_load_dwordx4 v6, s[76:79], s66 offen lds
    buffer_load_dwordx4 v7, s[76:79], s66 offen offset:1024 lds
    s_cmp_eq_u32 s63, s62
    s_cselect_b32 s66, s61, s63
    s_waitcnt vmcnt(6)
    buffer_load_dwordx4 v[192:195], v2, s[68:71], s9 offen offset:0 sc1
    buffer_load_dwordx4 v[196:199], v2, s[68:71], s9 offen offset:1024 sc1
    s_add_u32 s9, s9, 2048
    s_cmp_eq_u32 s9, s65
    s_cselect_b32 s9, s64, s9
    s_add_u32 m0, s14, 4096
    s_add_u32 s63, s66, 16384
    buffer_load_dwordx4 v6, s[76:79], s66 offen lds
    buffer_load_dwordx4 v7, s[76:79], s66 offen offset:1024 lds
    s_cmp_eq_u32 s63, s62
    s_cselect_b32 s66, s61, s63
    s_waitcnt vmcnt(6)
    buffer_load_dwordx4 v[200:203], v2, s[68:71], s9 offen offset:0 sc1
    buffer_load_dwordx4 v[204:207], v2, s[68:71], s9 offen offset:1024 sc1
    s_add_u32 s9, s9, 2048
    s_cmp_eq_u32 s9, s65
    s_cselect_b32 s9, s64, s9
    s_add_u32 m0, s14, 6144
    s_add_u32 s63, s66, 16384
    buffer_load_dwordx4 v6, s[76:79], s66 offen lds
    buffer_load_dwordx4 v7, s[76:79], s66 offen offset:1024 lds
    s_cmp_eq_u32 s63, s62
    s_cselect_b32 s66, s61, s63
    s_waitcnt vmcnt(6)
    buffer_load_dwordx4 v[208:211], v2, s[68:71], s9 offen offset:0 sc1
    buffer_load_dwordx4 v[212:215], v2, s[68:71], s9 offen offset:1024 sc1
    s_add_u32 s9, s9, 2048
    s_cmp_eq_u32 s9, s65
    s_cselect_b32 s9, s64, s9
    s_waitcnt vmcnt(4)
    buffer_load_dwordx4 v[216:219], v2, s[68:71], s9 offen offset:0 sc1
    buffer_load_dwordx4 v[220:223], v2, s[68:71], s9 offen offset:1024 sc1
    s_add_u32 s9, s9, 2048
    s_cmp_eq_u32 s9, s65
    s_cselect_b32 s9, s64, s9
    s_waitcnt vmcnt(2)
    s_waitcnt vmcnt(0)
    s_barrier
    s_cmp_lg_u32 s6, 0
    s_cbranch_scc1 L_nohint
    s_mov_b64 exec, 1
    buffer_store_dword v22, off, s[68:71], s73 sc1
    s_mov_b64 exec, -1
L_nohint:
    s_barrier
    ds_read2_b32 v[12:13], v3 offset0:0 offset1:32
    ds_read_b64_tr_b16 v[32:33], v54 offset:8192
    ds_read_b64_tr_b16 v[34:35], v54 offset:9216
    ds_read_b64_tr_b16 v[36:37], v55 offset:8192
    ds_read_b64_tr_b16 v[38:39], v55 offset:9216
    ds_read_b64_tr_b16 v[40:41], v54 offset:10240
    ds_read_b64_tr_b16 v[42:43], v54 offset:11264
    ds_read_b64_tr_b16 v[44:45], v55 offset:10240
    ds_read_b64_tr_b16 v[46:47], v55 offset:11264
    s_waitcnt lgkmcnt(4)
    v_mfma_f32_32x32x16_bf16 v[64:79], v[32:35], v[224:227], v[64:79]
    ds_read_b64_tr_b16 v[56:57], v54 offset:12288
    v_mfma_f32_32x32x16_bf16 v[80:95], v[32:35], v[228:231], v[80:95]
    ds_read_b64_tr_b16 v[58:59], v54 offset:13312
    v_mfma_f32_32x32x16_bf16 v[96:111], v[36:39], v[224:227], v[96:111]
    ds_read_b64_tr_b16 v[60:61], v55 offset:12288
    v_mfma_f32_32x32x16_bf16 v[112:127], v[36:39], v[228:231], v[112:127]
    ds_read_b64_tr_b16 v[62:63], v55 offset:13312
    buffer_load_dword v24, v23, s[68:71], s72 offen sc1
    s_waitcnt lgkmcnt(4)
    v_mfma_f32_32x32x16_bf16 v[64:79], v[40:43], v[232:235], v[64:79]
    ds_read_b64_tr_b16 v[32:33], v54 offset:14336
    v_mfma_f32_32x32x16_bf16 v[80:95], v[40:43], v[236:239], v[80:95]
    ds_read_b64_tr_b16 v[34:35], v54 offset:15360
    v_mfma_f32_32x32x16_bf16 v[96:111], v[44:47], v[232:235], v[96:111]
    ds_read_b64_tr_b16 v[36:37], v55 offset:14336
    v_mfma_f32_32x32x16_bf16 v[112:127], v[44:47], v[236:239], v[112:127]
    ds_read_b64_tr_b16 v[38:39], v55 offset:15360
    s_waitcnt lgkmcnt(4)
    v_mfma_f32_32x32x16_bf16 v[64:79], v[56:59], v[240:243], v[64:79]
    ds_read_b64_tr_b16 v[40:41], v54 offset:0
    v_mfma_f32_32x32x16_bf16 v[80:95], v[56:59], v[244:247], v[80:95]
    ds_read_b64_tr_b16 v[42:43], v54 offset:1024
    v_mfma_f32_32x32x16_bf16 v[96:111], v[60:63], v[240:243], v[96:111]
    ds_read_b64_tr_b16 v[44:45], v55 offset:0
    v_mfma_f32_32x32x16_bf16 v[112:127], v[60:63], v[244:247], v[112:127]
    ds_read_b64_tr_b16 v[46:47], v55 offset:1024
    s_waitcnt lgkmcnt(4)
    v_mfma_f32_32x32x16_bf16 v[64:79], v[32:35], v[248:251], v[64:79]
    ds_read_b64_tr_b16 v[56:57], v54 offset:2048
    v_mfma_f32_32x32x16_bf16 v[80:95], v[32:35], v[252:255], v[80:95]
    ds_read_b64_tr_b16 v[58:59], v54 offset:3072
    v_mfma_f32_32x32x16_bf16 v[96:111], v[36:39], v[248:251], v[96:111]
    ds_read_b64_tr_b16 v[60:61], v55 offset:2048
    v_mfma_f32_32x32x16_bf16 v[112:127], v[36:39], v[252:255], v[112:127]
    ds_read_b64_tr_b16 v[62:63], v55 offset:3072
    s_waitcnt lgkmcnt(4)
    v_mfma_f32_32x32x16_bf16 v[64:79], v[40:43], v[192:195], v[64:79]
    ds_read_b64_tr_b16 v[32:33], v54 offset:4096
    v_mfma_f32_32x32x16_bf16 v[80:95], v[40:43], v[196:199], v[80:95]
    ds_read_b64_tr_b16 v[34:35], v54 offset:5120
    v_mfma_f32_32x32x16_bf16 v[96:111], v[44:47], v[192:195], v[96:111]
    ds_read_b64_tr_b16 v[36:37], v55 offset:4096
    v_mfma_f32_32x32x16_bf16 v[112:127], v[44:47], v[196:199], v[112:127]
    ds_read_b64_tr_b16 v[38:39], v55 offset:5120
    s_waitcnt lgkmcnt(4)
    v_mfma_f32_32x32x16_bf16 v[64:79], v[56:59], v[200:203], v[64:79]
    ds_read_b64_tr_b16 v[40:41], v54 offset:6144
    v_mfma_f32_32x32x16_bf16 v[80:95], v[56:59], v[204:207], v[80:95]
    ds_read_b64_tr_b16 v[42:43], v54 offset:7168
    v_mfma_f32_32x32x16_bf16 v[96:111], v[60:63], v[200:203], v[96:111]
    ds_read_b64_tr_b16 v[44:45], v55 offset:6144
    v_mfma_f32_32x32x16_bf16 v[112:127], v[60:63], v[204:207], v[112:127]
    ds_read_b64_tr_b16 v[46:47], v55 offset:7168
    s_setprio 2
    s_waitcnt vmcnt(0)
    v_cmp_ne_u32 vcc, s59, v24
    s_cbranch_vccnz L_hint
L_hint_ok:
    buffer_load_dwordx4 v[224:227], v2, s[68:71], s12 offen offset:0 sc1
    buffer_load_dwordx4 v[228:231], v2, s[68:71], s12 offen offset:2048 sc1
    buffer_load_dwordx4 v[232:235], v2, s[68:71], s56 offen offset:0 sc1
    buffer_load_dwordx4 v[236:239], v2, s[68:71], s56 offen offset:2048 sc1
    buffer_load_dwordx4 v[240:243], v2, s[68:71], s57 offen offset:0 sc1
    buffer_load_dwordx4 v[244:247], v2, s[68:71], s57 offen offset:2048 sc1
    buffer_load_dwordx4 v[248:251], v2, s[68:71], s13 offen offset:0 sc1
    buffer_load_dwordx4 v[252:255], v2, s[68:71], s13 offen offset:2048 sc1
    s_waitcnt lgkmcnt(4)
    v_mfma_f32_32x32x16_bf16 v[64:79], v[32:35], v[208:211], v[64:79]
    v_mfma_f32_32x32x16_bf16 v[80:95], v[32:35], v[212:215], v[80:95]
    v_mfma_f32_32x32x16_bf16 v[96:111], v[36:39], v[208:211], v[96:111]
    v_mfma_f32_32x32x16_bf16 v[112:127], v[36:39], v[212:215], v[112:127]
    s_waitcnt lgkmcnt(0)
    v_mfma_f32_32x32x16_bf16 v[64:79], v[40:43], v[216:219], v[64:79]
    v_mfma_f32_32x32x16_bf16 v[80:95], v[40:43], v[220:223], v[80:95]
    v_mfma_f32_32x32x16_bf16 v[96:111], v[44:47], v[216:219], v[96:111]
    v_mfma_f32_32x32x16_bf16 v[112:127], v[44:47], v[220:223], v[112:127]
    s_setprio 2
    buffer_load_dwordx4 v[192:195], v2, s[68:71], s12 offen offset:1024 sc1
    buffer_load_dwordx4 v[196:199], v2, s[68:71], s12 offen offset:3072 sc1
    buffer_load_dwordx4 v[200:203], v2, s[68:71], s56 offen offset:1024 sc1
    buffer_load_dwordx4 v[204:207], v2, s[68:71], s56 offen offset:3072 sc1
    buffer_load_dwordx4 v[208:211], v2, s[68:71], s57 offen offset:1024 sc1
    buffer_load_dwordx4 v[212:215], v2, s[68:71], s57 offen offset:3072 sc1
    buffer_load_dwordx4 v[216:219], v2, s[68:71], s13 offen offset:1024 sc1
    buffer_load_dwordx4 v[220:223], v2, s[68:71], s13 offen offset:3072 sc1
    v_sub_f32 v16, 1.0, v12
    v_sub_f32 v18, 1.0, v13
    v_pk_mul_f32 v[64:65], v[64:65], v[16:17] op_sel_hi:[1,0]
    v_pk_mul_f32 v[66:67], v[66:67], v[16:17] op_sel_hi:[1,0]
    v_pk_mul_f32 v[68:69], v[68:69], v[16:17] op_sel_hi:[1,0]
    v_pk_mul_f32 v[70:71], v[70:71], v[16:17] op_sel_hi:[1,0]
    v_pk_mul_f32 v[72:73], v[72:73], v[16:17] op_sel_hi:[1,0]
    v_pk_mul_f32 v[74:75], v[74:75], v[16:17] op_sel_hi:[1,0]
    v_pk_mul_f32 v[76:77], v[76:77], v[16:17] op_sel_hi:[1,0]
    v_pk_mul_f32 v[78:79], v[78:79], v[16:17] op_sel_hi:[1,0]
    v_pk_mul_f32 v[96:97], v[96:97], v[16:17] op_sel_hi:[1,0]
    v_pk_mul_f32 v[98:99], v[98:99], v[16:17] op_sel_hi:[1,0]
    v_pk_mul_f32 v[100:101], v[100:101], v[16:17] op_sel_hi:[1,0]
    v_pk_mul_f32 v[102:103], v[102:103], v[16:17] op_sel_hi:[1,0]
    v_pk_mul_f32 v[104:105], v[104:105], v[16:17] op_sel_hi:[1,0]
    v_pk_mul_f32 v[106:107], v[106:107], v[16:17] op_sel_hi:[1,0]
    v_pk_mul_f32 v[108:109], v[108:109], v[16:17] op_sel_hi:[1,0]
    v_pk_mul_f32 v[110:111], v[110:111], v[16:17] op_sel_hi:[1,0]
    v_pk_mul_f32 v[80:81], v[80:81], v[18:19] op_sel_hi:[1,0]
    v_pk_mul_f32 v[82:83], v[82:83], v[18:19] op_sel_hi:[1,0]
    v_pk_mul_f32 v[84:85], v[84:85], v[18:19] op_sel_hi:[1,0]
    v_pk_mul_f32 v[86:87], v[86:87], v[18:19] op_sel_hi:[1,0]
    v_pk_mul_f32 v[88:89], v[88:89], v[18:19] op_sel_hi:[1,0]
    v_pk_mul_f32 v[90:91], v[90:91], v[18:19] op_sel_hi:[1,0]
    v_pk_mul_f32 v[92:93], v[92:93], v[18:19] op_sel_hi:[1,0]
    v_pk_mul_f32 v[94:95], v[94:95], v[18:19] op_sel_hi:[1,0]
    v_pk_mul_f32 v[112:113], v[112:113], v[18:19] op_sel_hi:[1,0]
    v_pk_mul_f32 v[114:115], v[114:115], v[18:19] op_sel_hi:[1,0]
    v_pk_mul_f32 v[116:117], v[116:117], v[18:19] op_sel_hi:[1,0]
    v_pk_mul_f32 v[118:119], v[118:119], v[18:19] op_sel_hi:[1,0]
    v_pk_mul_f32 v[120:121], v[120:121], v[18:19] op_sel_hi:[1,0]
    v_pk_mul_f32 v[122:123], v[122:123], v[18:19] op_sel_hi:[1,0]
    v_pk_mul_f32 v[124:125], v[124:125], v[18:19] op_sel_hi:[1,0]
    v_pk_mul_f32 v[126:127], v[126:127], v[18:19] op_sel_hi:[1,0]
    s_waitcnt vmcnt(12)
    v_max3_u32 v20, v224, v228, v232
    v_max_u32 v20, v20, v236
    v_cmp_eq_u32 vcc, -1, v20
    s_cbranch_vccnz L_oq0
L_oqk0:
    v_mfma_f32_32x32x16_bf16 v[64:79], v[128:131], v[224:227], v[64:79]
    v_mfma_f32_32x32x16_bf16 v[64:79], v[136:139], v[228:231], v[64:79]
    v_mfma_f32_32x32x16_bf16 v[64:79], v[144:147], v[232:235], v[64:79]
    v_mfma_f32_32x32x16_bf16 v[64:79], v[152:155], v[236:239], v[64:79]
    v_mfma_f32_32x32x16_bf16 v[96:111], v[132:135], v[224:227], v[96:111]
    v_mfma_f32_32x32x16_bf16 v[96:111], v[140:143], v[228:231], v[96:111]
    v_mfma_f32_32x32x16_bf16 v[96:111], v[148:151], v[232:235], v[96:111]
    v_mfma_f32_32x32x16_bf16 v[96:111], v[156:159], v[236:239], v[96:111]
    s_waitcnt vmcnt(8)
    v_max3_u32 v20, v240, v244, v248
    v_max_u32 v20, v20, v252
    v_cmp_eq_u32 vcc, -1, v20
    s_cbranch_vccnz L_oq1
L_oqk1:
    v_mfma_f32_32x32x16_bf16 v[64:79], v[160:163], v[240:243], v[64:79]
    v_mfma_f32_32x32x16_bf16 v[64:79], v[168:171], v[244:247], v[64:79]
    v_mfma_f32_32x32x16_bf16 v[64:79], v[176:179], v[248:251], v[64:79]
    v_mfma_f32_32x32x16_bf16 v[64:79], v[184:187], v[252:255], v[64:79]
    v_mfma_f32_32x32x16_bf16 v[96:111], v[164:167], v[240:243], v[96:111]
    v_mfma_f32_32x32x16_bf16 v[96:111], v[172:175], v[244:247], v[96:111]
    v_mfma_f32_32x32x16_bf16 v[96:111], v[180:183], v[248:251], v[96:111]
    v_mfma_f32_32x32x16_bf16 v[96:111], v[188:191], v[252:255], v[96:111]
    s_waitcnt vmcnt(4)
    v_max3_u32 v20, v192, v196, v200
    v_max_u32 v20, v20, v204
    v_cmp_eq_u32 vcc, -1, v20
    s_cbranch_vccnz L_oq2
L_oqk2:
    v_mfma_f32_32x32x16_bf16 v[80:95], v[128:131], v[192:195], v[80:95]
    s_nop 1
    ds_write_b128 v14, v[64:67] offset:0
    v_mfma_f32_32x32x16_bf16 v[80:95], v[136:139], v[196:199], v[80:95]
    ds_write_b128 v14, v[68:71] offset:32
    v_mfma_f32_32x32x16_bf16 v[80:95], v[144:147], v[200:203], v[80:95]
    ds_write_b128 v14, v[72:75] offset:64
    v_mfma_f32_32x32x16_bf16 v[80:95], v[152:155], v[204:207], v[80:95]
    ds_write_b128 v14, v[76:79] offset:96
    v_mfma_f32_32x32x16_bf16 v[112:127], v[132:135], v[192:195], v[112:127]
    ds_write_b128 v14, v[96:99] offset:128
    v_mfma_f32_32x32x16_bf16 v[112:127], v[140:143], v[196:199], v[112:127]
    ds_write_b128 v14, v[100:103] offset:160
    v_mfma_f32_32x32x16_bf16 v[112:127], v[148:151], v[200:203], v[112:127]
    ds_write_b128 v14, v[104:107] offset:192
    v_mfma_f32_32x32x16_bf16 v[112:127], v[156:159], v[204:207], v[112:127]
    ds_write_b128 v14, v[108:111] offset:224
    s_waitcnt vmcnt(0)
    v_max3_u32 v20, v208, v212, v216
    v_max_u32 v20, v20, v220
    v_cmp_eq_u32 vcc, -1, v20
    s_cbranch_vccnz L_oq3
L_oqk3:
    v_mfma_f32_32x32x16_bf16 v[80:95], v[160:163], v[208:211], v[80:95]
    v_mfma_f32_32x32x16_bf16 v[80:95], v[168:171], v[212:215], v[80:95]
    v_mfma_f32_32x32x16_bf16 v[80:95], v[176:179], v[216:219], v[80:95]
    v_mfma_f32_32x32x16_bf16 v[80:95], v[184:187], v[220:223], v[80:95]
    v_mfma_f32_32x32x16_bf16 v[112:127], v[164:167], v[208:211], v[112:127]
    s_nop 9
    v_mfma_f32_32x32x16_bf16 v[112:127], v[172:175], v[212:215], v[112:127]
    ds_write_b128 v14, v[80:83] offset:8704
    ds_write_b128 v14, v[84:87] offset:8736
    v_mfma_f32_32x32x16_bf16 v[112:127], v[180:183], v[216:219], v[112:127]
    ds_write_b128 v14, v[88:91] offset:8768
    ds_write_b128 v14, v[92:95] offset:8800
    v_mfma_f32_32x32x16_bf16 v[112:127], v[188:191], v[220:223], v[112:127]
    s_nop 11
    ds_write_b128 v14, v[112:115] offset:8832
    ds_write_b128 v14, v[116:119] offset:8864
    ds_write_b128 v14, v[120:123] offset:8896
    ds_write_b128 v14, v[124:127] offset:8928
    s_waitcnt lgkmcnt(0)
    s_barrier
    ds_read_b128 v[12:15], v8 offset:0
    ds_read_b128 v[16:19], v8 offset:16
    ds_read_b128 v[20:23], v8 offset:17408
    ds_read_b128 v[24:27], v8 offset:17424
    ds_read_b128 v[28:31], v9 offset:0
    ds_read_b128 v[32:35], v9 offset:16
    ds_read_b128 v[36:39], v9 offset:17408
    ds_read_b128 v[40:43], v9 offset:17424
    s_waitcnt lgkmcnt(4)
    v_pk_add_f32 v[12:13], v[12:13], v[20:21]
    v_pk_add_f32 v[14:15], v[14:15], v[22:23]
    v_pk_add_f32 v[16:17], v[16:17], v[24:25]
    v_pk_add_f32 v[18:19], v[18:19], v[26:27]
    s_waitcnt lgkmcnt(0)
    v_pk_add_f32 v[28:29], v[28:29], v[36:37]
    v_pk_add_f32 v[30:31], v[30:31], v[38:39]
    v_pk_add_f32 v[32:33], v[32:33], v[40:41]
    v_pk_add_f32 v[34:35], v[34:35], v[42:43]
    v_pk_add_f32 v[12:13], v[12:13], v[28:29]
    v_pk_add_f32 v[14:15], v[14:15], v[30:31]
    v_pk_add_f32 v[16:17], v[16:17], v[32:33]
    v_pk_add_f32 v[18:19], v[18:19], v[34:35]
    v_cvt_pk_bf16_f32 v20, v12, v13
    v_cvt_pk_bf16_f32 v21, v14, v15
    v_cvt_pk_bf16_f32 v22, v16, v17
    v_cvt_pk_bf16_f32 v23, v18, v19
    buffer_store_dwordx4 v[20:23], v10, s[84:87], s10 offen
    s_lshl_b32 s8, s4, 6
    s_lshl_b32 s9, s5, 3
    s_add_u32 s8, s8, s9
    s_add_u32 s8, s8, s3
    s_cmp_lg_u32 s8, 5
    s_cbranch_scc1 L_notag
    v_mov_b32 v4, s59
    s_mov_b32 s8, 180224
    s_mov_b64 exec, 1
    buffer_store_dword v4, off, s[68:71], s8 sc1
L_notag:
    s_endpgm
L_oq0:
    s_waitcnt vmcnt(0)
L_oq0_a:
    buffer_load_dwordx4 v[224:227], v2, s[68:71], s12 offen offset:0 sc1
    buffer_load_dwordx4 v[228:231], v2, s[68:71], s12 offen offset:2048 sc1
    buffer_load_dwordx4 v[232:235], v2, s[68:71], s56 offen offset:0 sc1
    buffer_load_dwordx4 v[236:239], v2, s[68:71], s56 offen offset:2048 sc1
    buffer_load_dwordx4 v[240:243], v2, s[68:71], s57 offen offset:0 sc1
    buffer_load_dwordx4 v[244:247], v2, s[68:71], s57 offen offset:2048 sc1
    buffer_load_dwordx4 v[248:251], v2, s[68:71], s13 offen offset:0 sc1
    buffer_load_dwordx4 v[252:255], v2, s[68:71], s13 offen offset:2048 sc1
    buffer_load_dwordx4 v[192:195], v2, s[68:71], s12 offen offset:1024 sc1
    buffer_load_dwordx4 v[196:199], v2, s[68:71], s12 offen offset:3072 sc1
    buffer_load_dwordx4 v[200:203], v2, s[68:71], s56 offen offset:1024 sc1
    buffer_load_dwordx4 v[204:207], v2, s[68:71], s56 offen offset:3072 sc1
    buffer_load_dwordx4 v[208:211], v2, s[68:71], s57 offen offset:1024 sc1
    buffer_load_dwordx4 v[212:215], v2, s[68:71], s57 offen offset:3072 sc1
    buffer_load_dwordx4 v[216:219], v2, s[68:71], s13 offen offset:1024 sc1
    buffer_load_dwordx4 v[220:223], v2, s[68:71], s13 offen offset:3072 sc1
    s_waitcnt vmcnt(12)
    v_max3_u32 v20, v224, v228, v232
    v_max_u32 v20, v20, v236
    v_cmp_eq_u32 vcc, -1, v20
    s_cbranch_vccz L_oqk0
    s_waitcnt vmcnt(0)
    s_sub_u32 s99, s99, 1
    s_cmp_le_i32 s99, 0
    s_cbranch_scc1 L_oqk0
    s_branch L_oq0_a
L_oq1:
    s_waitcnt vmcnt(0)
L_oq1_a:
    buffer_load_dwordx4 v[240:243], v2, s[68:71], s57 offen offset:0 sc1
    buffer_load_dwordx4 v[244:247], v2, s[68:71], s57 offen offset:2048 sc1
    buffer_load_dwordx4 v[248:251], v2, s[68:71], s13 offen offset:0 sc1
    buffer_load_dwordx4 v[252:255], v2, s[68:71], s13 offen offset:2048 sc1
    buffer_load_dwordx4 v[192:195], v2, s[68:71], s12 offen offset:1024 sc1
    buffer_load_dwordx4 v[196:199], v2, s[68:71], s12 offen offset:3072 sc1
    buffer_load_dwordx4 v[200:203], v2, s[68:71], s56 offen offset:1024 sc1
    buffer_load_dwordx4 v[204:207], v2, s[68:71], s56 offen offset:3072 sc1
    buffer_load_dwordx4 v[208:211], v2, s[68:71], s57 offen offset:1024 sc1
    buffer_load_dwordx4 v[212:215], v2, s[68:71], s57 offen offset:3072 sc1
    buffer_load_dwordx4 v[216:219], v2, s[68:71], s13 offen offset:1024 sc1
    buffer_load_dwordx4 v[220:223], v2, s[68:71], s13 offen offset:3072 sc1
    s_waitcnt vmcnt(8)
    v_max3_u32 v20, v240, v244, v248
    v_max_u32 v20, v20, v252
    v_cmp_eq_u32 vcc, -1, v20
    s_cbranch_vccz L_oqk1
    s_waitcnt vmcnt(0)
    s_sub_u32 s99, s99, 1
    s_cmp_le_i32 s99, 0
    s_cbranch_scc1 L_oqk1
    s_branch L_oq1_a
L_oq2:
    s_waitcnt vmcnt(0)
L_oq2_a:
    buffer_load_dwordx4 v[192:195], v2, s[68:71], s12 offen offset:1024 sc1
    buffer_load_dwordx4 v[196:199], v2, s[68:71], s12 offen offset:3072 sc1
    buffer_load_dwordx4 v[200:203], v2, s[68:71], s56 offen offset:1024 sc1
    buffer_load_dwordx4 v[204:207], v2, s[68:71], s56 offen offset:3072 sc1
    buffer_load_dwordx4 v[208:211], v2, s[68:71], s57 offen offset:1024 sc1
    buffer_load_dwordx4 v[212:215], v2, s[68:71], s57 offen offset:3072 sc1
    buffer_load_dwordx4 v[216:219], v2, s[68:71], s13 offen offset:1024 sc1
    buffer_load_dwordx4 v[220:223], v2, s[68:71], s13 offen offset:3072 sc1
    s_waitcnt vmcnt(4)
    v_max3_u32 v20, v192, v196, v200
    v_max_u32 v20, v20, v204
    v_cmp_eq_u32 vcc, -1, v20
    s_cbranch_vccz L_oqk2
    s_waitcnt vmcnt(0)
    s_sub_u32 s99, s99, 1
    s_cmp_le_i32 s99, 0
    s_cbranch_scc1 L_oqk2
    s_branch L_oq2_a
L_oq3:
    s_waitcnt vmcnt(0)
L_oq3_a:
    buffer_load_dwordx4 v[208:211], v2, s[68:71], s57 offen offset:1024 sc1
    buffer_load_dwordx4 v[212:215], v2, s[68:71], s57 offen offset:3072 sc1
    buffer_load_dwordx4 v[216:219], v2, s[68:71], s13 offen offset:1024 sc1
    buffer_load_dwordx4 v[220:223], v2, s[68:71], s13 offen offset:3072 sc1
    s_waitcnt vmcnt(0)
    v_max3_u32 v20, v208, v212, v216
    v_max_u32 v20, v20, v220
    v_cmp_eq_u32 vcc, -1, v20
    s_cbranch_vccz L_oqk3
    s_waitcnt vmcnt(0)
    s_sub_u32 s99, s99, 1
    s_cmp_le_i32 s99, 0
    s_cbranch_scc1 L_oqk3
    s_branch L_oq3_a
L_hint:
    buffer_load_dword v24, v23, s[68:71], s72 offen sc1
    s_waitcnt vmcnt(0)
    v_cmp_ne_u32 vcc, s59, v24
    s_cbranch_vccz L_hint_ok
    s_sub_u32 s99, s99, 1
    s_cmp_le_i32 s99, 0
    s_cbranch_scc1 L_hint_ok
    s_branch L_hint
L_G_idle:
    s_waitcnt vmcnt(0)
    s_mov_b64 exec, 1
    ds_add_u32 v12, v8 offset:20
    s_mov_b64 exec, -1
L_G_idle_a:
    s_sleep 8
    ds_read_b32 v14, v12 offset:20
    s_waitcnt lgkmcnt(0)
    v_readfirstlane_b32 s8, v14
    s_nop 0
    s_cmp_ge_u32 s8, 4
    s_cbranch_scc0 L_G_idle_a
    s_branch L_G_ffn1_end
L_end:
    s_endpgm
L_slow0:
    s_waitcnt vmcnt(0) lgkmcnt(0)
    s_mov_b32 s62, 0
    v_mov_b32 v7, 0xff800000
L_slow0_a:
    buffer_load_dwordx4 v[40:43], v2, s[68:71], s62 offen offset:0 sc1
    buffer_load_dwordx4 v[44:47], v3, s[68:71], s62 offen offset:1024 sc1
    buffer_load_dwordx4 v[48:51], v1, s[68:71], s62 offen offset:1024 sc1
    s_waitcnt vmcnt(0)
    v_max3_u32 v6, v40, v44, v48
    v_cmp_eq_u32 vcc, -1, v6
    s_cbranch_vccz L_slow0_c
    s_sub_u32 s65, s65, 1
    s_cmp_le_i32 s65, 0
    s_cbranch_scc1 L_slow0_c
    s_branch L_slow0_a
L_slow0_c:
    v_mfma_f32_32x32x16_bf16 v[80:95], v[40:43], v[32:35], 0
    s_nop 15
    v_max3_f32 v7, v7, v80, v81
    v_max3_f32 v7, v7, v82, v83
    v_max3_f32 v7, v7, v84, v85
    v_max3_f32 v7, v7, v86, v87
    v_max3_f32 v7, v7, v88, v89
    v_max3_f32 v7, v7, v90, v91
    v_max3_f32 v7, v7, v92, v93
    v_max3_f32 v7, v7, v94, v95
    s_add_u32 s62, s62, 2304
    s_cmp_lt_u32 s62, 147456
    s_cbranch_scc1 L_slow0_a
    v_mov_b32 v6, v7
    s_nop 1
    v_permlane32_swap_b32 v6, v7
    v_max_f32 v7, v6, v7
    v_sub_f32 v104, 0, v7
    v_mov_b32 v128, 0
    v_sub_f32 v105, 0, v7
    v_mov_b32 v129, 0
    v_sub_f32 v106, 0, v7
    v_mov_b32 v130, 0
    v_sub_f32 v107, 0, v7
    v_mov_b32 v131, 0
    v_sub_f32 v108, 0, v7
    v_mov_b32 v132, 0
    v_sub_f32 v109, 0, v7
    v_mov_b32 v133, 0
    v_sub_f32 v110, 0, v7
    v_mov_b32 v134, 0
    v_sub_f32 v111, 0, v7
    v_mov_b32 v135, 0
    v_sub_f32 v112, 0, v7
    v_mov_b32 v136, 0
    v_sub_f32 v113, 0, v7
    v_mov_b32 v137, 0
    v_sub_f32 v114, 0, v7
    v_mov_b32 v138, 0
    v_sub_f32 v115, 0, v7
    v_mov_b32 v139, 0
    v_sub_f32 v116, 0, v7
    v_mov_b32 v140, 0
    v_sub_f32 v117, 0, v7
    v_mov_b32 v141, 0
    v_sub_f32 v118, 0, v7
    v_mov_b32 v142, 0
    v_sub_f32 v119, 0, v7
    v_mov_b32 v143, 0
    s_mov_b32 s62, 0
L_slow0_b:
    buffer_load_dwordx4 v[40:43], v2, s[68:71], s62 offen offset:0 sc1
    buffer_load_dwordx4 v[44:47], v3, s[68:71], s62 offen offset:1024 sc1
    buffer_load_dwordx4 v[48:51], v1, s[68:71], s62 offen offset:1024 sc1
    s_waitcnt vmcnt(0)
    v_mfma_f32_32x32x16_bf16 v[80:95], v[40:43], v[32:35], v[104:119]
    s_nop 15
    v_exp_f32 v80, v80
    v_exp_f32 v81, v81
    v_exp_f32 v82, v82
    v_exp_f32 v83, v83
    v_exp_f32 v84, v84
    v_exp_f32 v85, v85
    v_exp_f32 v86, v86
    v_exp_f32 v87, v87
    v_exp_f32 v88, v88
    v_exp_f32 v89, v89
    v_exp_f32 v90, v90
    v_exp_f32 v91, v91
    v_exp_f32 v92, v92
    v_exp_f32 v93, v93
    v_exp_f32 v94, v94
    v_exp_f32 v95, v95
    s_nop 0
    v_cvt_pk_bf16_f32 v96, v80, v81
    v_cvt_pk_bf16_f32 v97, v82, v83
    v_cvt_pk_bf16_f32 v98, v84, v85
    v_cvt_pk_bf16_f32 v99, v86, v87
    v_cvt_pk_bf16_f32 v100, v88, v89
    v_cvt_pk_bf16_f32 v101, v90, v91
    v_cvt_pk_bf16_f32 v102, v92, v93
    v_cvt_pk_bf16_f32 v103, v94, v95
    s_nop 1
    v_mfma_f32_32x32x16_bf16 v[128:143], v[44:47], v[96:99], v[128:143]
    v_mfma_f32_32x32x16_bf16 v[128:143], v[48:51], v[100:103], v[128:143]
    s_nop 15
    s_add_u32 s62, s62, 2304
    s_cmp_lt_u32 s62, 147456
    s_cbranch_scc1 L_slow0_b
    v_mov_b32 v224, v128
    v_mov_b32 v225, v129
    v_mov_b32 v226, v130
    v_mov_b32 v227, v131
    v_mov_b32 v228, v132
    v_mov_b32 v229, v133
    v_mov_b32 v230, v134
    v_mov_b32 v231, v135
    v_mov_b32 v232, v136
    v_rcp_f32 v6, v232
    s_nop 1
    s_branch L_ok0
L_slow1:
    s_waitcnt vmcnt(0)
    s_mov_b32 s62, 0
    v_mov_b32 v7, 0xff800000
L_slow1_a:
    buffer_load_dwordx4 v[40:43], v2, s[68:71], s62 offen offset:0 sc1
    buffer_load_dwordx4 v[44:47], v3, s[68:71], s62 offen offset:1024 sc1
    buffer_load_dwordx4 v[48:51], v1, s[68:71], s62 offen offset:1024 sc1
    s_waitcnt vmcnt(0)
    v_max3_u32 v6, v40, v44, v48
    v_cmp_eq_u32 vcc, -1, v6
    s_cbranch_vccz L_slow1_c
    s_sub_u32 s65, s65, 1
    s_cmp_le_i32 s65, 0
    s_cbranch_scc1 L_slow1_c
    s_branch L_slow1_a
L_slow1_c:
    v_mfma_f32_32x32x16_bf16 v[80:95], v[40:43], v[36:39], 0
    s_nop 15
    v_max3_f32 v7, v7, v80, v81
    v_max3_f32 v7, v7, v82, v83
    v_max3_f32 v7, v7, v84, v85
    v_max3_f32 v7, v7, v86, v87
    v_max3_f32 v7, v7, v88, v89
    v_max3_f32 v7, v7, v90, v91
    v_max3_f32 v7, v7, v92, v93
    v_max3_f32 v7, v7, v94, v95
    s_add_u32 s62, s62, 2304
    s_cmp_lt_u32 s62, 147456
    s_cbranch_scc1 L_slow1_a
    v_mov_b32 v6, v7
    s_nop 1
    v_permlane32_swap_b32 v6, v7
    v_max_f32 v7, v6, v7
    v_sub_f32 v104, 0, v7
    v_mov_b32 v128, 0
    v_sub_f32 v105, 0, v7
    v_mov_b32 v129, 0
    v_sub_f32 v106, 0, v7
    v_mov_b32 v130, 0
    v_sub_f32 v107, 0, v7
    v_mov_b32 v131, 0
    v_sub_f32 v108, 0, v7
    v_mov_b32 v132, 0
    v_sub_f32 v109, 0, v7
    v_mov_b32 v133, 0
    v_sub_f32 v110, 0, v7
    v_mov_b32 v134, 0
    v_sub_f32 v111, 0, v7
    v_mov_b32 v135, 0
    v_sub_f32 v112, 0, v7
    v_mov_b32 v136, 0
    v_sub_f32 v113, 0, v7
    v_mov_b32 v137, 0
    v_sub_f32 v114, 0, v7
    v_mov_b32 v138, 0
    v_sub_f32 v115, 0, v7
    v_mov_b32 v139, 0
    v_sub_f32 v116, 0, v7
    v_mov_b32 v140, 0
    v_sub_f32 v117, 0, v7
    v_mov_b32 v141, 0
    v_sub_f32 v118, 0, v7
    v_mov_b32 v142, 0
    v_sub_f32 v119, 0, v7
    v_mov_b32 v143, 0
    s_mov_b32 s62, 0
L_slow1_b:
    buffer_load_dwordx4 v[40:43], v2, s[68:71], s62 offen offset:0 sc1
    buffer_load_dwordx4 v[44:47], v3, s[68:71], s62 offen offset:1024 sc1
    buffer_load_dwordx4 v[48:51], v1, s[68:71], s62 offen offset:1024 sc1
    s_waitcnt vmcnt(0)
    v_mfma_f32_32x32x16_bf16 v[80:95], v[40:43], v[36:39], v[104:119]
    s_nop 15
    v_exp_f32 v80, v80
    v_exp_f32 v81, v81
    v_exp_f32 v82, v82
    v_exp_f32 v83, v83
    v_exp_f32 v84, v84
    v_exp_f32 v85, v85
    v_exp_f32 v86, v86
    v_exp_f32 v87, v87
    v_exp_f32 v88, v88
    v_exp_f32 v89, v89
    v_exp_f32 v90, v90
    v_exp_f32 v91, v91
    v_exp_f32 v92, v92
    v_exp_f32 v93, v93
    v_exp_f32 v94, v94
    v_exp_f32 v95, v95
    s_nop 0
    v_cvt_pk_bf16_f32 v96, v80, v81
    v_cvt_pk_bf16_f32 v97, v82, v83
    v_cvt_pk_bf16_f32 v98, v84, v85
    v_cvt_pk_bf16_f32 v99, v86, v87
    v_cvt_pk_bf16_f32 v100, v88, v89
    v_cvt_pk_bf16_f32 v101, v90, v91
    v_cvt_pk_bf16_f32 v102, v92, v93
    v_cvt_pk_bf16_f32 v103, v94, v95
    s_nop 1
    v_mfma_f32_32x32x16_bf16 v[128:143], v[44:47], v[96:99], v[128:143]
    v_mfma_f32_32x32x16_bf16 v[128:143], v[48:51], v[100:103], v[128:143]
    s_nop 15
    s_add_u32 s62, s62, 2304
    s_cmp_lt_u32 s62, 147456
    s_cbranch_scc1 L_slow1_b
    v_mov_b32 v240, v128
    v_mov_b32 v241, v129
    v_mov_b32 v242, v130
    v_mov_b32 v243, v131
    v_mov_b32 v244, v132
    v_mov_b32 v245, v133
    v_mov_b32 v246, v134
    v_mov_b32 v247, v135
    v_mov_b32 v248, v136
    v_rcp_f32 v6, v248
    s_nop 1
    s_branch L_ok1
L_code_end:
.section .rodata,"a"
.p2align 6
.amdhsa_kernel gated_mix__grouped_kv_mqa__dense_activation_squared_relu__prompt_kernel
  .amdhsa_next_free_vgpr 256
  .amdhsa_next_free_sgpr 102
  .amdhsa_accum_offset 256
  .amdhsa_group_segment_fixed_size 0
  .amdhsa_kernarg_size 112
  .amdhsa_user_sgpr_count 2
  .amdhsa_user_sgpr_kernarg_segment_ptr 1
  .amdhsa_system_sgpr_workgroup_id_x 1
.end_amdhsa_kernel
```
